```python
import torch

def _softmax(x, axis=-1):
    return torch.softmax(x, dim=axis)
def _gelu(x):
    return torch.nn.functional.gelu(x, approximate="tanh")
def _silu(x):
    return torch.nn.functional.silu(x)
def _sigmoid(x):
    return torch.sigmoid(x)
def _layernorm(x, axis=-1, eps=1e-5):
    m = x.mean(dim=axis, keepdim=True)
    v = x.var(dim=axis, keepdim=True, unbiased=False)
    return (x - m) / torch.sqrt(v + eps)
def _scatter_add(tgt, idx, src, axis=0):
    return tgt.clone().index_add_(axis, idx, src)
def _segment_sum(src, seg, n):
    out = torch.zeros((n,) + src.shape[1:], dtype=src.dtype)
    return out.index_add_(0, seg, src)
def _pad(x, pw):
    flat = tuple(v for pair in reversed(pw) for v in pair)
    return torch.nn.functional.pad(x, flat)

kernel_name = 'parallel_sum__compressed_kv_cla__dense_activation_gelu__prompt'

def setup_inputs():

    _w = (lambda a: (lambda t: t.to(torch.bfloat16) if t.is_floating_point() else t)(torch.as_tensor(a)))
    def _A_setup():
        B, H, Sq, Sk, D, M = 1, 32, 2048, 2048, 128, 512
        Dc = 4 * D
        return {
            "x": _w((lambda *s: torch.randn(*s, dtype=torch.bfloat16) * 0.05)(B, Sq, M)),
            "c_kv": _w((lambda *s: torch.randn(*s, dtype=torch.bfloat16) * 0.4)(B, Sk, Dc)),
            "w_q": _w((lambda *s: torch.randn(*s, dtype=torch.bfloat16) * 3.2)(M, H, D) * (M ** -0.5)),
            "w_uk": _w((lambda *s: torch.randn(*s, dtype=torch.bfloat16) * 3.2)(Dc, H, D) * (Dc ** -0.5)),
            "w_uv": _w((lambda *s: torch.randn(*s, dtype=torch.bfloat16) * 0.4)(Dc, H, D) * (Dc ** -0.5)),
            "w_o": _w((lambda *s: torch.randn(*s, dtype=torch.bfloat16) * 0.4)(H, D, M) * ((H * D) ** -0.5)),
        }
    _A_in = _A_setup()

    def _B_setup():
        B, S, D, F = 1, 2048, 512, 1376
        return {
            "x": _w((lambda *s: torch.randn(*s, dtype=torch.bfloat16) * 0.05)(B, S, D)),
            "w1": _w((lambda *s: torch.randn(*s, dtype=torch.bfloat16) * 0.4)(D, F) * (D ** -0.5)),
            "b1": _w((lambda *s: torch.randn(*s, dtype=torch.bfloat16) * 12.8)(F) * 0.01),
            "w2": _w((lambda *s: torch.randn(*s, dtype=torch.bfloat16) * 0.2)(F, D) * (F ** -0.5)),
            "b2": _w((lambda *s: torch.randn(*s, dtype=torch.bfloat16) * 3.2)(D) * 0.01),
        }
    _B_in = _B_setup()

    return {
        "A_x": _A_in["x"],
        "A_c_kv": _A_in["c_kv"],
        "A_w_q": _A_in["w_q"],
        "A_w_uk": _A_in["w_uk"],
        "A_w_uv": _A_in["w_uv"],
        "A_w_o": _A_in["w_o"],
        "B_x": _B_in["x"],
        "B_w1": _B_in["w1"],
        "B_b1": _B_in["b1"],
        "B_w2": _B_in["w2"],
        "B_b2": _B_in["b2"],
    }

def reference(A_x, A_c_kv, A_w_q, A_w_uk, A_w_uv, A_w_o, B_x, B_w1, B_b1, B_w2, B_b2):
    def _A_ref(x, c_kv, w_q, w_uk, w_uv, w_o):
        B, Sq, M = x.shape[0], x.shape[1], x.shape[2]
        Sk = c_kv.shape[1]
        H, D = w_q.shape[1], w_q.shape[2]
        q = torch.einsum("bqm,mhd->bhqd", x, w_q)
        k = torch.einsum("bkc,chd->bhkd", c_kv, w_uk)
        v = torch.einsum("bkc,chd->bhkd", c_kv, w_uv)
        scores = torch.einsum("bhqd,bhkd->bhqk", q, k) * (D ** -0.5)
        off = Sk - Sq
        qi = torch.arange(Sq)[:, None]
        kj = torch.arange(Sk)[None, :]
        cmask = kj <= (qi + off)
        scores = torch.where(cmask[None, None], scores, -1e9)
        p = _softmax(scores, axis=-1)
        ctx = torch.einsum("bhqk,bhkd->bhqd", p, v)
        return torch.einsum("bhqd,hdm->bqm", ctx, w_o)

    def _B_ref(x, w1, b1, w2, b2):
        h = torch.einsum("bsd,df->bsf", x, w1) + b1
        h = _gelu(h)
        return torch.einsum("bsf,fd->bsd", h, w2) + b2

    x = A_x
    xn = _layernorm(x, axis=-1)
    return x + _A_ref(xn, A_c_kv, A_w_q, A_w_uk, A_w_uv, A_w_o) + _B_ref(xn, B_w1, B_b1, B_w2, B_b2)
```

```asm
; @launch kernel=ln_kernel grid=(1248,1,1) block=(256,1,1) lds=0
; @launch kernel=gemma_kernel grid=(896,1,1) block=(256,1,1) lds=73728
; @launch kernel=attn_kernel grid=(256,1,1) block=(512,1,1) lds=137216
; @launch kernel=gemmc_kernel grid=(256,1,1) block=(256,1,1) lds=49152
; @launch kernel=reduce_kernel grid=(1024,1,1) block=(256,1,1) lds=0
.amdgcn_target "amdgcn-amd-amdhsa--gfx950"
.text
.globl ln_kernel
.p2align 8
.type ln_kernel,@function
ln_kernel:
    s_cmp_ge_u32 s2, 1248
    s_cbranch_scc1 LN_EXIT
    s_cmp_ge_u32 s2, 1024
    s_cbranch_scc1 LN_PF
    s_load_dwordx2 s[4:5], s[0:1], 0
    s_load_dwordx2 s[6:7], s[0:1], 104
    s_load_dwordx2 s[16:17], s[0:1], 8
    v_lshrrev_b32 v1, 6, v0
    v_and_b32 v2, 63, v0
    s_and_b32 s3, s2, 511
    s_lshl_b32 s3, s3, 2
    v_add_u32 v1, s3, v1
    v_lshlrev_b32 v3, 10, v1
    v_lshl_add_u32 v3, v2, 4, v3
    v_lshrrev_b32 v20, 7, v1
    v_lshlrev_b32 v20, 17, v20
    v_and_b32 v21, 127, v1
    v_lshl_add_u32 v21, v2, 7, v21
    v_lshl_add_u32 v20, v21, 4, v20
    s_waitcnt lgkmcnt(0)
    s_cmp_ge_u32 s2, 512
    s_cbranch_scc1 LN_COPY
    s_mov_b32 s8, s4
    s_mov_b32 s9, s5
    s_mov_b32 s10, 2097152
    s_mov_b32 s11, 0x00020000
    s_add_u32 s6, s6, 0
    s_addc_u32 s7, s7, 0
    s_mov_b32 s12, s6
    s_mov_b32 s13, s7
    s_mov_b32 s14, 2097152
    s_mov_b32 s15, 0x00020000
    buffer_load_dwordx4 v[4:7], v3, s[8:11], 0 offen
    s_waitcnt vmcnt(0)
    v_lshlrev_b32 v8, 16, v4
    v_and_b32 v9, 0xffff0000, v4
    v_lshlrev_b32 v10, 16, v5
    v_and_b32 v11, 0xffff0000, v5
    v_lshlrev_b32 v12, 16, v6
    v_and_b32 v13, 0xffff0000, v6
    v_lshlrev_b32 v14, 16, v7
    v_and_b32 v15, 0xffff0000, v7
    v_add_f32 v16, v8, v9
    v_add_f32 v16, v16, v10
    v_add_f32 v16, v16, v11
    v_add_f32 v16, v16, v12
    v_add_f32 v16, v16, v13
    v_add_f32 v16, v16, v14
    v_add_f32 v16, v16, v15
    s_nop 1
    v_add_f32_dpp v16, v16, v16 row_shr:1 row_mask:0xf bank_mask:0xf bound_ctrl:0
    s_nop 1
    v_add_f32_dpp v16, v16, v16 row_shr:2 row_mask:0xf bank_mask:0xf bound_ctrl:0
    s_nop 1
    v_add_f32_dpp v16, v16, v16 row_shr:4 row_mask:0xf bank_mask:0xf bound_ctrl:0
    s_nop 1
    v_add_f32_dpp v16, v16, v16 row_shr:8 row_mask:0xf bank_mask:0xf bound_ctrl:0
    s_nop 1
    v_add_f32_dpp v16, v16, v16 row_bcast:15 row_mask:0xa bank_mask:0xf
    s_nop 1
    v_add_f32_dpp v16, v16, v16 row_bcast:31 row_mask:0xc bank_mask:0xf
    s_nop 1
    v_readlane_b32 s20, v16, 63
    s_nop 3
    v_mov_b32 v17, s20
    v_mul_f32 v17, 0x3b000000, v17
    v_sub_f32 v24, v8, v17
    v_sub_f32 v25, v9, v17
    v_sub_f32 v26, v10, v17
    v_sub_f32 v27, v11, v17
    v_sub_f32 v28, v12, v17
    v_sub_f32 v29, v13, v17
    v_sub_f32 v30, v14, v17
    v_sub_f32 v31, v15, v17
    v_mul_f32 v24, v24, v24
    v_mul_f32 v25, v25, v25
    v_mul_f32 v26, v26, v26
    v_mul_f32 v27, v27, v27
    v_mul_f32 v28, v28, v28
    v_mul_f32 v29, v29, v29
    v_mul_f32 v30, v30, v30
    v_mul_f32 v31, v31, v31
    v_add_f32 v18, v24, v25
    v_add_f32 v18, v18, v26
    v_add_f32 v18, v18, v27
    v_add_f32 v18, v18, v28
    v_add_f32 v18, v18, v29
    v_add_f32 v18, v18, v30
    v_add_f32 v18, v18, v31
    s_nop 1
    v_add_f32_dpp v18, v18, v18 row_shr:1 row_mask:0xf bank_mask:0xf bound_ctrl:0
    s_nop 1
    v_add_f32_dpp v18, v18, v18 row_shr:2 row_mask:0xf bank_mask:0xf bound_ctrl:0
    s_nop 1
    v_add_f32_dpp v18, v18, v18 row_shr:4 row_mask:0xf bank_mask:0xf bound_ctrl:0
    s_nop 1
    v_add_f32_dpp v18, v18, v18 row_shr:8 row_mask:0xf bank_mask:0xf bound_ctrl:0
    s_nop 1
    v_add_f32_dpp v18, v18, v18 row_bcast:15 row_mask:0xa bank_mask:0xf
    s_nop 1
    v_add_f32_dpp v18, v18, v18 row_bcast:31 row_mask:0xc bank_mask:0xf
    s_nop 1
    v_readlane_b32 s21, v18, 63
    s_nop 3
    v_mov_b32 v18, s21
    v_mul_f32 v18, 0x3b000000, v18
    v_cvt_pk_bf16_f32 v17, v17, v17
    v_lshlrev_b32 v17, 16, v17
    v_cvt_pk_bf16_f32 v18, v18, v18
    v_lshlrev_b32 v18, 16, v18
    v_add_f32 v18, 0x3727c5ac, v18
    v_cvt_pk_bf16_f32 v18, v18, v18
    v_lshlrev_b32 v18, 16, v18
    v_sqrt_f32 v18, v18
    s_nop 0
    v_cvt_pk_bf16_f32 v18, v18, v18
    v_lshlrev_b32 v18, 16, v18
    v_rcp_f32 v19, v18
    v_sub_f32 v24, v8, v17
    v_sub_f32 v25, v9, v17
    v_sub_f32 v26, v10, v17
    v_sub_f32 v27, v11, v17
    v_sub_f32 v28, v12, v17
    v_sub_f32 v29, v13, v17
    v_sub_f32 v30, v14, v17
    v_sub_f32 v31, v15, v17
    v_cvt_pk_bf16_f32 v32, v24, v25
    v_cvt_pk_bf16_f32 v33, v26, v27
    v_cvt_pk_bf16_f32 v34, v28, v29
    v_cvt_pk_bf16_f32 v35, v30, v31
    v_lshlrev_b32 v24, 16, v32
    v_and_b32 v25, 0xffff0000, v32
    v_lshlrev_b32 v26, 16, v33
    v_and_b32 v27, 0xffff0000, v33
    v_lshlrev_b32 v28, 16, v34
    v_and_b32 v29, 0xffff0000, v34
    v_lshlrev_b32 v30, 16, v35
    v_and_b32 v31, 0xffff0000, v35
    v_mul_f32 v36, v24, v19
    v_mul_f32 v37, v25, v19
    v_mul_f32 v38, v26, v19
    v_mul_f32 v39, v27, v19
    v_mul_f32 v40, v28, v19
    v_mul_f32 v41, v29, v19
    v_mul_f32 v42, v30, v19
    v_mul_f32 v43, v31, v19
    v_fma_f32 v44, -v36, v18, v24
    v_fma_f32 v45, -v37, v18, v25
    v_fma_f32 v46, -v38, v18, v26
    v_fma_f32 v47, -v39, v18, v27
    v_fma_f32 v48, -v40, v18, v28
    v_fma_f32 v49, -v41, v18, v29
    v_fma_f32 v50, -v42, v18, v30
    v_fma_f32 v51, -v43, v18, v31
    v_fma_f32 v36, v44, v19, v36
    v_fma_f32 v37, v45, v19, v37
    v_fma_f32 v38, v46, v19, v38
    v_fma_f32 v39, v47, v19, v39
    v_fma_f32 v40, v48, v19, v40
    v_fma_f32 v41, v49, v19, v41
    v_fma_f32 v42, v50, v19, v42
    v_fma_f32 v43, v51, v19, v43
    v_cvt_pk_bf16_f32 v4, v36, v37
    v_cvt_pk_bf16_f32 v5, v38, v39
    v_cvt_pk_bf16_f32 v6, v40, v41
    v_cvt_pk_bf16_f32 v7, v42, v43
    buffer_store_dwordx4 v[4:7], v20, s[12:15], 0 offen
    s_endpgm
LN_COPY:
    s_mov_b32 s8, s16
    s_mov_b32 s9, s17
    s_mov_b32 s10, 2097152
    s_mov_b32 s11, 0x00020000
    s_add_u32 s6, s6, 2097152
    s_addc_u32 s7, s7, 0
    s_mov_b32 s12, s6
    s_mov_b32 s13, s7
    s_mov_b32 s14, 2097152
    s_mov_b32 s15, 0x00020000
    buffer_load_dwordx4 v[4:7], v3, s[8:11], 0 offen
    s_waitcnt vmcnt(0)
    buffer_store_dwordx4 v[4:7], v20, s[12:15], 0 offen
    s_endpgm
LN_PF:
    s_sub_u32 s3, s2, 1024
    s_and_b32 s4, s3, 7
    s_lshr_b32 s5, s3, 3
    s_lshr_b32 s6, s5, 2
    s_lshl_b32 s6, s6, 3
    s_add_u32 s6, s6, s4
    s_and_b32 s5, s5, 3
    s_cmp_ge_u32 s6, 54
    s_cbranch_scc1 LN_EXIT
    s_load_dwordx2 s[8:9], s[0:1], 16
    s_load_dwordx2 s[10:11], s[0:1], 24
    s_load_dwordx2 s[12:13], s[0:1], 32
    s_load_dwordx2 s[14:15], s[0:1], 56
    s_waitcnt lgkmcnt(0)
    s_cmp_lt_u32 s6, 6
    s_cbranch_scc1 LN_PF_FFN
    s_sub_u32 s7, s6, 6
    s_lshr_b32 s20, s7, 4
    s_and_b32 s7, s7, 15
    s_cmp_eq_u32 s20, 1
    s_cselect_b32 s8, s10, s8
    s_cselect_b32 s9, s11, s9
    s_cmp_eq_u32 s20, 2
    s_cselect_b32 s8, s12, s8
    s_cselect_b32 s9, s13, s9
    s_mov_b32 s16, s8
    s_mov_b32 s17, s9
    s_mov_b32 s18, 4194304
    s_mov_b32 s19, 0x00020000
    s_mov_b32 s21, 8192
    s_branch LN_PF_GO
LN_PF_FFN:
    s_mov_b32 s16, s14
    s_mov_b32 s17, s15
    s_mov_b32 s18, 1409024
    s_mov_b32 s19, 0x00020000
    s_mov_b32 s7, s6
    s_mov_b32 s21, 2752
LN_PF_GO:
    s_lshl_b32 s22, s5, 7
    v_lshrrev_b32 v1, 5, v0
    v_add_u32 v1, s22, v1
    v_mul_lo_u32 v1, v1, s21
    v_and_b32 v2, 31, v0
    v_lshl_add_u32 v1, v2, 4, v1
    s_lshl_b32 s7, s7, 9
    s_lshl_b32 s23, s21, 3
    buffer_load_dwordx4 v[4:7], v1, s[16:19], s7 offen
    s_add_u32 s7, s7, s23
    buffer_load_dwordx4 v[8:11], v1, s[16:19], s7 offen
    s_add_u32 s7, s7, s23
    buffer_load_dwordx4 v[12:15], v1, s[16:19], s7 offen
    s_add_u32 s7, s7, s23
    buffer_load_dwordx4 v[16:19], v1, s[16:19], s7 offen
    s_add_u32 s7, s7, s23
    buffer_load_dwordx4 v[20:23], v1, s[16:19], s7 offen
    s_add_u32 s7, s7, s23
    buffer_load_dwordx4 v[24:27], v1, s[16:19], s7 offen
    s_add_u32 s7, s7, s23
    buffer_load_dwordx4 v[28:31], v1, s[16:19], s7 offen
    s_add_u32 s7, s7, s23
    buffer_load_dwordx4 v[32:35], v1, s[16:19], s7 offen
    s_add_u32 s7, s7, s23
    buffer_load_dwordx4 v[4:7], v1, s[16:19], s7 offen
    s_add_u32 s7, s7, s23
    buffer_load_dwordx4 v[8:11], v1, s[16:19], s7 offen
    s_add_u32 s7, s7, s23
    buffer_load_dwordx4 v[12:15], v1, s[16:19], s7 offen
    s_add_u32 s7, s7, s23
    buffer_load_dwordx4 v[16:19], v1, s[16:19], s7 offen
    s_add_u32 s7, s7, s23
    buffer_load_dwordx4 v[20:23], v1, s[16:19], s7 offen
    s_add_u32 s7, s7, s23
    buffer_load_dwordx4 v[24:27], v1, s[16:19], s7 offen
    s_add_u32 s7, s7, s23
    buffer_load_dwordx4 v[28:31], v1, s[16:19], s7 offen
    s_add_u32 s7, s7, s23
    buffer_load_dwordx4 v[32:35], v1, s[16:19], s7 offen
    s_add_u32 s7, s7, s23
LN_EXIT:
    s_endpgm
.globl gemma_kernel
.p2align 8
.type gemma_kernel,@function
gemma_kernel:
    s_cmp_ge_u32 s2, 896
    s_cbranch_scc1 GA_EXIT
    s_and_b32 s36, s2, 7
    s_lshr_b32 s37, s2, 3
    s_and_b32 s43, s37, 15
    s_lshr_b32 s37, s37, 4
    s_lshl_b32 s37, s37, 3
    s_add_u32 s44, s37, s36
    s_cmp_ge_u32 s44, 54
    s_cbranch_scc1 GA_EXIT
    s_load_dwordx2 s[52:53], s[0:1], 16
    s_load_dwordx2 s[54:55], s[0:1], 24
    s_load_dwordx2 s[56:57], s[0:1], 32
    s_load_dwordx2 s[58:59], s[0:1], 56
    s_load_dwordx2 s[60:61], s[0:1], 64
    s_load_dwordx2 s[62:63], s[0:1], 104
    v_lshrrev_b32 v1, 6, v0
    s_nop 0
    v_readfirstlane_b32 s3, v1
    s_nop 3
    s_lshr_b32 s47, s3, 1
    s_and_b32 s48, s3, 1
    s_waitcnt lgkmcnt(0)
    s_mov_b32 s20, s60
    s_mov_b32 s21, s61
    s_mov_b32 s22, 2752
    s_mov_b32 s23, 0x00020000
    s_cmp_lt_u32 s44, 6
    s_cbranch_scc1 GA_FFN
    s_sub_u32 s36, s44, 6
    s_lshr_b32 s37, s36, 4
    s_and_b32 s36, s36, 15
    s_lshl_b32 s45, s36, 5
    s_mov_b32 s42, 0
    s_mov_b32 s40, 8192
    s_mov_b32 s46, 1048576
    s_cmp_eq_u32 s37, 1
    s_cselect_b32 s64, s54, s52
    s_cselect_b32 s65, s55, s53
    s_cmp_eq_u32 s37, 2
    s_cselect_b32 s64, s56, s64
    s_cselect_b32 s65, s57, s65
    s_mov_b32 s12, s64
    s_mov_b32 s13, s65
    s_mov_b32 s14, 4194304
    s_mov_b32 s15, 0x00020000
    s_cmp_eq_u32 s37, 0
    s_cselect_b32 s35, 0, 2097152
    s_add_u32 s66, s62, s35
    s_addc_u32 s67, s63, 0
    s_mov_b32 s8, s66
    s_mov_b32 s9, s67
    s_mov_b32 s10, 2097152
    s_mov_b32 s11, 0x00020000
    s_mul_i32 s37, s37, 16777216
    s_add_u32 s37, s37, 4194304
    s_add_u32 s68, s62, s37
    s_addc_u32 s69, s63, 0
    s_mov_b32 s16, s68
    s_mov_b32 s17, s69
    s_mov_b32 s18, 16777216
    s_mov_b32 s19, 0x00020000
    s_lshl_b32 s37, s36, 9
    s_branch GA_COMMON
GA_FFN:
    s_lshl_b32 s45, s44, 5
    s_add_u32 s45, s45, 512
    s_mov_b32 s42, 1
    s_mov_b32 s40, 2752
    s_mov_b32 s46, 1441792
    s_mov_b32 s12, s58
    s_mov_b32 s13, s59
    s_mov_b32 s14, 1409024
    s_mov_b32 s15, 0x00020000
    s_add_u32 s66, s62, 0
    s_addc_u32 s67, s63, 0
    s_mov_b32 s8, s66
    s_mov_b32 s9, s67
    s_mov_b32 s10, 2097152
    s_mov_b32 s11, 0x00020000
    s_add_u32 s68, s62, 54525952
    s_addc_u32 s69, s63, 0
    s_mov_b32 s16, s68
    s_mov_b32 s17, s69
    s_mov_b32 s18, 23068672
    s_mov_b32 s19, 0x00020000
    s_lshl_b32 s37, s44, 9
GA_COMMON:
    s_add_u32 s36, s3, 0
    s_mul_i32 s36, s36, 2
    s_mul_i32 s36, s36, s40
    s_add_u32 s24, s36, s37
    s_add_u32 s36, s3, 4
    s_mul_i32 s36, s36, 2
    s_mul_i32 s36, s36, s40
    s_add_u32 s25, s36, s37
    s_add_u32 s36, s3, 8
    s_mul_i32 s36, s36, 2
    s_mul_i32 s36, s36, s40
    s_add_u32 s26, s36, s37
    s_add_u32 s36, s3, 12
    s_mul_i32 s36, s36, 2
    s_mul_i32 s36, s36, s40
    s_add_u32 s27, s36, s37
    s_mul_i32 s34, s40, 32
    s_mul_i32 s36, s43, 131072
    s_lshl_b32 s37, s3, 11
    s_add_u32 s36, s36, s37
    s_add_u32 s28, s36, 0
    s_mul_i32 s36, s43, 131072
    s_lshl_b32 s37, s3, 11
    s_add_u32 s36, s36, s37
    s_add_u32 s29, s36, 1024
    v_and_b32 v1, 63, v0
    v_lshrrev_b32 v10, 5, v1
    v_and_b32 v11, 15, v1
    v_lshrrev_b32 v12, 2, v11
    v_and_b32 v13, 3, v11
    v_bfe_u32 v14, v1, 4, 1
    v_lshl_add_u32 v15, v10, 3, v12
    v_mul_u32_u24 v15, 512, v15
    v_lshlrev_b32 v14, 5, v14
    v_lshl_add_u32 v14, v13, 3, v14
    v_add_u32 v15, v15, v14
    s_mul_i32 s36, s47, 4
    s_add_u32 s37, s36, 0
    v_xor_b32 v2, s37, v12
    v_lshl_add_u32 v2, v2, 6, v15
    s_add_u32 s37, s36, 1
    v_xor_b32 v3, s37, v12
    v_lshl_add_u32 v3, v3, 6, v15
    s_add_u32 s37, s36, 2
    v_xor_b32 v4, s37, v12
    v_lshl_add_u32 v4, v4, 6, v15
    s_add_u32 s37, s36, 3
    v_xor_b32 v5, s37, v12
    v_lshl_add_u32 v5, v5, 6, v15
    v_and_b32 v12, 31, v1
    s_lshl_b32 s36, s48, 6
    v_add_u32 v12, s36, v12
    v_lshlrev_b32 v12, 4, v12
    v_lshl_add_u32 v12, v10, 11, v12
    v_add_u32 v6, 16384, v12
    v_lshrrev_b32 v10, 5, v1
    v_and_b32 v11, 31, v1
    v_lshrrev_b32 v12, 2, v11
    s_and_b32 s36, s3, 1
    s_lshl_b32 s36, s36, 1
    v_add_u32 v13, s36, v10
    v_xor_b32 v12, v12, v13
    v_and_b32 v11, 3, v11
    v_lshlrev_b32 v11, 4, v11
    v_lshl_add_u32 v11, v12, 6, v11
    v_mul_lo_u32 v10, v10, s40
    v_add_u32 v8, v10, v11
    v_lshlrev_b32 v9, 4, v1
    s_mov_b32 s31, 16
    s_mov_b32 s32, 0
    s_mov_b32 s33, 49152
    s_add_u32 s33, s33, 24576
    s_cmp_eq_u32 s33, 73728
    s_cselect_b32 s33, 0, s33
    s_lshl_b32 s36, s3, 10
    s_add_u32 s38, s33, s36
    s_lshl_b32 s36, s3, 11
    s_add_u32 s39, s33, s36
    s_add_u32 s39, s39, 16384
    s_add_u32 m0, s38, 0
    s_nop 0
    buffer_load_dwordx4 v8, s[12:15], s24 offen lds
    s_add_u32 s24, s24, s34
    s_add_u32 m0, s38, 4096
    s_nop 0
    buffer_load_dwordx4 v8, s[12:15], s25 offen lds
    s_add_u32 s25, s25, s34
    s_add_u32 m0, s38, 8192
    s_nop 0
    buffer_load_dwordx4 v8, s[12:15], s26 offen lds
    s_add_u32 s26, s26, s34
    s_add_u32 m0, s38, 12288
    s_nop 0
    buffer_load_dwordx4 v8, s[12:15], s27 offen lds
    s_add_u32 s27, s27, s34
    s_add_u32 m0, s39, 0
    s_nop 0
    buffer_load_dwordx4 v9, s[8:11], s28 offen lds
    s_add_u32 s28, s28, 8192
    s_add_u32 m0, s39, 1024
    s_nop 0
    buffer_load_dwordx4 v9, s[8:11], s29 offen lds
    s_add_u32 s29, s29, 8192
    s_add_u32 s33, s33, 24576
    s_cmp_eq_u32 s33, 73728
    s_cselect_b32 s33, 0, s33
    s_lshl_b32 s36, s3, 10
    s_add_u32 s38, s33, s36
    s_lshl_b32 s36, s3, 11
    s_add_u32 s39, s33, s36
    s_add_u32 s39, s39, 16384
    s_add_u32 m0, s38, 0
    s_nop 0
    buffer_load_dwordx4 v8, s[12:15], s24 offen lds
    s_add_u32 s24, s24, s34
    s_add_u32 m0, s38, 4096
    s_nop 0
    buffer_load_dwordx4 v8, s[12:15], s25 offen lds
    s_add_u32 s25, s25, s34
    s_add_u32 m0, s38, 8192
    s_nop 0
    buffer_load_dwordx4 v8, s[12:15], s26 offen lds
    s_add_u32 s26, s26, s34
    s_add_u32 m0, s38, 12288
    s_nop 0
    buffer_load_dwordx4 v8, s[12:15], s27 offen lds
    s_add_u32 s27, s27, s34
    s_add_u32 m0, s39, 0
    s_nop 0
    buffer_load_dwordx4 v9, s[8:11], s28 offen lds
    s_add_u32 s28, s28, 8192
    s_add_u32 m0, s39, 1024
    s_nop 0
    buffer_load_dwordx4 v9, s[8:11], s29 offen lds
    s_add_u32 s29, s29, 8192
    s_add_u32 s33, s33, 24576
    s_cmp_eq_u32 s33, 73728
    s_cselect_b32 s33, 0, s33
    s_lshl_b32 s36, s3, 10
    s_add_u32 s38, s33, s36
    s_lshl_b32 s36, s3, 11
    s_add_u32 s39, s33, s36
    s_add_u32 s39, s39, 16384
    v_mov_b32 v64, 0
    v_mov_b32 v65, 0
    v_mov_b32 v66, 0
    v_mov_b32 v67, 0
    v_mov_b32 v68, 0
    v_mov_b32 v69, 0
    v_mov_b32 v70, 0
    v_mov_b32 v71, 0
    v_mov_b32 v72, 0
    v_mov_b32 v73, 0
    v_mov_b32 v74, 0
    v_mov_b32 v75, 0
    v_mov_b32 v76, 0
    v_mov_b32 v77, 0
    v_mov_b32 v78, 0
    v_mov_b32 v79, 0
    v_mov_b32 v80, 0
    v_mov_b32 v81, 0
    v_mov_b32 v82, 0
    v_mov_b32 v83, 0
    v_mov_b32 v84, 0
    v_mov_b32 v85, 0
    v_mov_b32 v86, 0
    v_mov_b32 v87, 0
    v_mov_b32 v88, 0
    v_mov_b32 v89, 0
    v_mov_b32 v90, 0
    v_mov_b32 v91, 0
    v_mov_b32 v92, 0
    v_mov_b32 v93, 0
    v_mov_b32 v94, 0
    v_mov_b32 v95, 0
    v_mov_b32 v96, 0
    v_mov_b32 v97, 0
    v_mov_b32 v98, 0
    v_mov_b32 v99, 0
    v_mov_b32 v100, 0
    v_mov_b32 v101, 0
    v_mov_b32 v102, 0
    v_mov_b32 v103, 0
    v_mov_b32 v104, 0
    v_mov_b32 v105, 0
    v_mov_b32 v106, 0
    v_mov_b32 v107, 0
    v_mov_b32 v108, 0
    v_mov_b32 v109, 0
    v_mov_b32 v110, 0
    v_mov_b32 v111, 0
    v_mov_b32 v112, 0
    v_mov_b32 v113, 0
    v_mov_b32 v114, 0
    v_mov_b32 v115, 0
    v_mov_b32 v116, 0
    v_mov_b32 v117, 0
    v_mov_b32 v118, 0
    v_mov_b32 v119, 0
    v_mov_b32 v120, 0
    v_mov_b32 v121, 0
    v_mov_b32 v122, 0
    v_mov_b32 v123, 0
    v_mov_b32 v124, 0
    v_mov_b32 v125, 0
    v_mov_b32 v126, 0
    v_mov_b32 v127, 0
    v_mov_b32 v128, 0
    v_mov_b32 v129, 0
    v_mov_b32 v130, 0
    v_mov_b32 v131, 0
    v_mov_b32 v132, 0
    v_mov_b32 v133, 0
    v_mov_b32 v134, 0
    v_mov_b32 v135, 0
    v_mov_b32 v136, 0
    v_mov_b32 v137, 0
    v_mov_b32 v138, 0
    v_mov_b32 v139, 0
    v_mov_b32 v140, 0
    v_mov_b32 v141, 0
    v_mov_b32 v142, 0
    v_mov_b32 v143, 0
    v_mov_b32 v144, 0
    v_mov_b32 v145, 0
    v_mov_b32 v146, 0
    v_mov_b32 v147, 0
    v_mov_b32 v148, 0
    v_mov_b32 v149, 0
    v_mov_b32 v150, 0
    v_mov_b32 v151, 0
    v_mov_b32 v152, 0
    v_mov_b32 v153, 0
    v_mov_b32 v154, 0
    v_mov_b32 v155, 0
    v_mov_b32 v156, 0
    v_mov_b32 v157, 0
    v_mov_b32 v158, 0
    v_mov_b32 v159, 0
    v_mov_b32 v160, 0
    v_mov_b32 v161, 0
    v_mov_b32 v162, 0
    v_mov_b32 v163, 0
    v_mov_b32 v164, 0
    v_mov_b32 v165, 0
    v_mov_b32 v166, 0
    v_mov_b32 v167, 0
    v_mov_b32 v168, 0
    v_mov_b32 v169, 0
    v_mov_b32 v170, 0
    v_mov_b32 v171, 0
    v_mov_b32 v172, 0
    v_mov_b32 v173, 0
    v_mov_b32 v174, 0
    v_mov_b32 v175, 0
    v_mov_b32 v176, 0
    v_mov_b32 v177, 0
    v_mov_b32 v178, 0
    v_mov_b32 v179, 0
    v_mov_b32 v180, 0
    v_mov_b32 v181, 0
    v_mov_b32 v182, 0
    v_mov_b32 v183, 0
    v_mov_b32 v184, 0
    v_mov_b32 v185, 0
    v_mov_b32 v186, 0
    v_mov_b32 v187, 0
    v_mov_b32 v188, 0
    v_mov_b32 v189, 0
    v_mov_b32 v190, 0
    v_mov_b32 v191, 0
    s_mov_b32 s30, 0
    s_sub_u32 s31, s31, 2
L_ga_loop:
    s_waitcnt vmcnt(6)
    s_barrier
    ds_read_b64_tr_b16 v[16:17], v2 offset:0
    ds_read_b64_tr_b16 v[18:19], v2 offset:2048
    ds_read_b128 v[48:51], v6 offset:0
    ds_read_b128 v[52:55], v6 offset:512
    ds_read_b64_tr_b16 v[20:21], v3 offset:0
    ds_read_b64_tr_b16 v[22:23], v3 offset:2048
    ds_read_b64_tr_b16 v[24:25], v4 offset:0
    ds_read_b64_tr_b16 v[26:27], v4 offset:2048
    ds_read_b64_tr_b16 v[28:29], v5 offset:0
    ds_read_b64_tr_b16 v[30:31], v5 offset:2048
    ds_read_b64_tr_b16 v[32:33], v2 offset:8192
    ds_read_b64_tr_b16 v[34:35], v2 offset:10240
    ds_read_b128 v[56:59], v6 offset:4096
    ds_read_b128 v[60:63], v6 offset:4608
    ds_read_b64_tr_b16 v[36:37], v3 offset:8192
    ds_read_b64_tr_b16 v[38:39], v3 offset:10240
    ds_read_b64_tr_b16 v[40:41], v4 offset:8192
    ds_read_b64_tr_b16 v[42:43], v4 offset:10240
    ds_read_b64_tr_b16 v[44:45], v5 offset:8192
    ds_read_b64_tr_b16 v[46:47], v5 offset:10240
    s_add_u32 s36, s32, 24576
    s_cmp_eq_u32 s36, 73728
    s_cselect_b32 s36, 0, s36
    s_sub_u32 s35, s36, s32
    s_mov_b32 s32, s36
    v_add_u32 v2, s35, v2
    v_add_u32 v3, s35, v3
    v_add_u32 v4, s35, v4
    v_add_u32 v5, s35, v5
    v_add_u32 v6, s35, v6
    s_waitcnt lgkmcnt(15)
    v_mfma_f32_32x32x16_bf16 v[64:79], v[16:19], v[48:51], v[64:79]
    s_add_u32 m0, s38, 0
    s_nop 0
    buffer_load_dwordx4 v8, s[12:15], s24 offen lds
    s_add_u32 s24, s24, s34
    v_mfma_f32_32x32x16_bf16 v[80:95], v[16:19], v[52:55], v[80:95]
    s_waitcnt lgkmcnt(14)
    v_mfma_f32_32x32x16_bf16 v[96:111], v[20:23], v[48:51], v[96:111]
    s_add_u32 m0, s38, 4096
    s_nop 0
    buffer_load_dwordx4 v8, s[12:15], s25 offen lds
    s_add_u32 s25, s25, s34
    v_mfma_f32_32x32x16_bf16 v[112:127], v[20:23], v[52:55], v[112:127]
    s_waitcnt lgkmcnt(12)
    v_mfma_f32_32x32x16_bf16 v[128:143], v[24:27], v[48:51], v[128:143]
    s_add_u32 m0, s38, 8192
    s_nop 0
    buffer_load_dwordx4 v8, s[12:15], s26 offen lds
    s_add_u32 s26, s26, s34
    v_mfma_f32_32x32x16_bf16 v[144:159], v[24:27], v[52:55], v[144:159]
    s_waitcnt lgkmcnt(10)
    v_mfma_f32_32x32x16_bf16 v[160:175], v[28:31], v[48:51], v[160:175]
    s_add_u32 m0, s38, 12288
    s_nop 0
    buffer_load_dwordx4 v8, s[12:15], s27 offen lds
    s_add_u32 s27, s27, s34
    v_mfma_f32_32x32x16_bf16 v[176:191], v[28:31], v[52:55], v[176:191]
    s_waitcnt lgkmcnt(7)
    v_mfma_f32_32x32x16_bf16 v[64:79], v[32:35], v[56:59], v[64:79]
    s_add_u32 m0, s39, 0
    s_nop 0
    buffer_load_dwordx4 v9, s[8:11], s28 offen lds
    s_add_u32 s28, s28, 8192
    s_waitcnt lgkmcnt(6)
    v_mfma_f32_32x32x16_bf16 v[80:95], v[32:35], v[60:63], v[80:95]
    s_waitcnt lgkmcnt(4)
    v_mfma_f32_32x32x16_bf16 v[96:111], v[36:39], v[56:59], v[96:111]
    s_add_u32 m0, s39, 1024
    s_nop 0
    buffer_load_dwordx4 v9, s[8:11], s29 offen lds
    s_add_u32 s29, s29, 8192
    v_mfma_f32_32x32x16_bf16 v[112:127], v[36:39], v[60:63], v[112:127]
    s_waitcnt lgkmcnt(2)
    v_mfma_f32_32x32x16_bf16 v[128:143], v[40:43], v[56:59], v[128:143]
    v_mfma_f32_32x32x16_bf16 v[144:159], v[40:43], v[60:63], v[144:159]
    s_waitcnt lgkmcnt(0)
    v_mfma_f32_32x32x16_bf16 v[160:175], v[44:47], v[56:59], v[160:175]
    v_mfma_f32_32x32x16_bf16 v[176:191], v[44:47], v[60:63], v[176:191]
    s_add_u32 s33, s33, 24576
    s_cmp_eq_u32 s33, 73728
    s_cselect_b32 s33, 0, s33
    s_lshl_b32 s36, s3, 10
    s_add_u32 s38, s33, s36
    s_lshl_b32 s36, s3, 11
    s_add_u32 s39, s33, s36
    s_add_u32 s39, s39, 16384
    s_add_u32 s30, s30, 1
    s_cmp_lt_u32 s30, s31
    s_cbranch_scc1 L_ga_loop
    s_waitcnt vmcnt(6)
    s_barrier
    ds_read_b64_tr_b16 v[16:17], v2 offset:0
    ds_read_b64_tr_b16 v[18:19], v2 offset:2048
    ds_read_b128 v[48:51], v6 offset:0
    ds_read_b128 v[52:55], v6 offset:512
    ds_read_b64_tr_b16 v[20:21], v3 offset:0
    ds_read_b64_tr_b16 v[22:23], v3 offset:2048
    ds_read_b64_tr_b16 v[24:25], v4 offset:0
    ds_read_b64_tr_b16 v[26:27], v4 offset:2048
    ds_read_b64_tr_b16 v[28:29], v5 offset:0
    ds_read_b64_tr_b16 v[30:31], v5 offset:2048
    ds_read_b64_tr_b16 v[32:33], v2 offset:8192
    ds_read_b64_tr_b16 v[34:35], v2 offset:10240
    ds_read_b128 v[56:59], v6 offset:4096
    ds_read_b128 v[60:63], v6 offset:4608
    ds_read_b64_tr_b16 v[36:37], v3 offset:8192
    ds_read_b64_tr_b16 v[38:39], v3 offset:10240
    ds_read_b64_tr_b16 v[40:41], v4 offset:8192
    ds_read_b64_tr_b16 v[42:43], v4 offset:10240
    ds_read_b64_tr_b16 v[44:45], v5 offset:8192
    ds_read_b64_tr_b16 v[46:47], v5 offset:10240
    s_add_u32 s36, s32, 24576
    s_cmp_eq_u32 s36, 73728
    s_cselect_b32 s36, 0, s36
    s_sub_u32 s35, s36, s32
    s_mov_b32 s32, s36
    v_add_u32 v2, s35, v2
    v_add_u32 v3, s35, v3
    v_add_u32 v4, s35, v4
    v_add_u32 v5, s35, v5
    v_add_u32 v6, s35, v6
    s_waitcnt lgkmcnt(15)
    v_mfma_f32_32x32x16_bf16 v[64:79], v[16:19], v[48:51], v[64:79]
    v_mfma_f32_32x32x16_bf16 v[80:95], v[16:19], v[52:55], v[80:95]
    s_waitcnt lgkmcnt(14)
    v_mfma_f32_32x32x16_bf16 v[96:111], v[20:23], v[48:51], v[96:111]
    v_mfma_f32_32x32x16_bf16 v[112:127], v[20:23], v[52:55], v[112:127]
    s_waitcnt lgkmcnt(12)
    v_mfma_f32_32x32x16_bf16 v[128:143], v[24:27], v[48:51], v[128:143]
    v_mfma_f32_32x32x16_bf16 v[144:159], v[24:27], v[52:55], v[144:159]
    s_waitcnt lgkmcnt(10)
    v_mfma_f32_32x32x16_bf16 v[160:175], v[28:31], v[48:51], v[160:175]
    v_mfma_f32_32x32x16_bf16 v[176:191], v[28:31], v[52:55], v[176:191]
    s_waitcnt lgkmcnt(7)
    v_mfma_f32_32x32x16_bf16 v[64:79], v[32:35], v[56:59], v[64:79]
    s_waitcnt lgkmcnt(6)
    v_mfma_f32_32x32x16_bf16 v[80:95], v[32:35], v[60:63], v[80:95]
    s_waitcnt lgkmcnt(4)
    v_mfma_f32_32x32x16_bf16 v[96:111], v[36:39], v[56:59], v[96:111]
    v_mfma_f32_32x32x16_bf16 v[112:127], v[36:39], v[60:63], v[112:127]
    s_waitcnt lgkmcnt(2)
    v_mfma_f32_32x32x16_bf16 v[128:143], v[40:43], v[56:59], v[128:143]
    v_mfma_f32_32x32x16_bf16 v[144:159], v[40:43], v[60:63], v[144:159]
    s_waitcnt lgkmcnt(0)
    v_mfma_f32_32x32x16_bf16 v[160:175], v[44:47], v[56:59], v[160:175]
    v_mfma_f32_32x32x16_bf16 v[176:191], v[44:47], v[60:63], v[176:191]
    s_waitcnt vmcnt(0)
    s_barrier
    ds_read_b64_tr_b16 v[16:17], v2 offset:0
    ds_read_b64_tr_b16 v[18:19], v2 offset:2048
    ds_read_b128 v[48:51], v6 offset:0
    ds_read_b128 v[52:55], v6 offset:512
    ds_read_b64_tr_b16 v[20:21], v3 offset:0
    ds_read_b64_tr_b16 v[22:23], v3 offset:2048
    ds_read_b64_tr_b16 v[24:25], v4 offset:0
    ds_read_b64_tr_b16 v[26:27], v4 offset:2048
    ds_read_b64_tr_b16 v[28:29], v5 offset:0
    ds_read_b64_tr_b16 v[30:31], v5 offset:2048
    ds_read_b64_tr_b16 v[32:33], v2 offset:8192
    ds_read_b64_tr_b16 v[34:35], v2 offset:10240
    ds_read_b128 v[56:59], v6 offset:4096
    ds_read_b128 v[60:63], v6 offset:4608
    ds_read_b64_tr_b16 v[36:37], v3 offset:8192
    ds_read_b64_tr_b16 v[38:39], v3 offset:10240
    ds_read_b64_tr_b16 v[40:41], v4 offset:8192
    ds_read_b64_tr_b16 v[42:43], v4 offset:10240
    ds_read_b64_tr_b16 v[44:45], v5 offset:8192
    ds_read_b64_tr_b16 v[46:47], v5 offset:10240
    s_add_u32 s36, s32, 24576
    s_cmp_eq_u32 s36, 73728
    s_cselect_b32 s36, 0, s36
    s_sub_u32 s35, s36, s32
    s_mov_b32 s32, s36
    v_add_u32 v2, s35, v2
    v_add_u32 v3, s35, v3
    v_add_u32 v4, s35, v4
    v_add_u32 v5, s35, v5
    v_add_u32 v6, s35, v6
    s_waitcnt lgkmcnt(15)
    v_mfma_f32_32x32x16_bf16 v[64:79], v[16:19], v[48:51], v[64:79]
    v_mfma_f32_32x32x16_bf16 v[80:95], v[16:19], v[52:55], v[80:95]
    s_waitcnt lgkmcnt(14)
    v_mfma_f32_32x32x16_bf16 v[96:111], v[20:23], v[48:51], v[96:111]
    v_mfma_f32_32x32x16_bf16 v[112:127], v[20:23], v[52:55], v[112:127]
    s_waitcnt lgkmcnt(12)
    v_mfma_f32_32x32x16_bf16 v[128:143], v[24:27], v[48:51], v[128:143]
    v_mfma_f32_32x32x16_bf16 v[144:159], v[24:27], v[52:55], v[144:159]
    s_waitcnt lgkmcnt(10)
    v_mfma_f32_32x32x16_bf16 v[160:175], v[28:31], v[48:51], v[160:175]
    v_mfma_f32_32x32x16_bf16 v[176:191], v[28:31], v[52:55], v[176:191]
    s_waitcnt lgkmcnt(7)
    v_mfma_f32_32x32x16_bf16 v[64:79], v[32:35], v[56:59], v[64:79]
    s_waitcnt lgkmcnt(6)
    v_mfma_f32_32x32x16_bf16 v[80:95], v[32:35], v[60:63], v[80:95]
    s_waitcnt lgkmcnt(4)
    v_mfma_f32_32x32x16_bf16 v[96:111], v[36:39], v[56:59], v[96:111]
    v_mfma_f32_32x32x16_bf16 v[112:127], v[36:39], v[60:63], v[112:127]
    s_waitcnt lgkmcnt(2)
    v_mfma_f32_32x32x16_bf16 v[128:143], v[40:43], v[56:59], v[128:143]
    v_mfma_f32_32x32x16_bf16 v[144:159], v[40:43], v[60:63], v[144:159]
    s_waitcnt lgkmcnt(0)
    v_mfma_f32_32x32x16_bf16 v[160:175], v[44:47], v[56:59], v[160:175]
    v_mfma_f32_32x32x16_bf16 v[176:191], v[44:47], v[60:63], v[176:191]
    s_waitcnt vmcnt(0)
    s_nop 15
    s_nop 7
    s_cmp_eq_u32 s42, 1
    s_cbranch_scc1 GA_EP_GELU
    v_and_b32 v10, 31, v1
    v_lshlrev_b32 v10, 4, v10
    v_lshrrev_b32 v11, 5, v1
    v_lshl_add_u32 v10, v11, 11, v10
    s_mul_i32 s36, s43, s46
    s_mul_i32 s37, s47, 16
    s_add_u32 s37, s37, s45
    s_lshl_b32 s37, s37, 11
    s_add_u32 s36, s36, s37
    s_lshl_b32 s37, s48, 10
    s_add_u32 s36, s36, s37
    v_cvt_pk_bf16_f32 v196, v64, v65
    v_cvt_pk_bf16_f32 v197, v66, v67
    v_cvt_pk_bf16_f32 v198, v68, v69
    v_cvt_pk_bf16_f32 v199, v70, v71
    s_nop 1
    v_permlane32_swap_b32 v196, v198
    v_permlane32_swap_b32 v197, v199
    s_add_u32 s37, s36, 0
    buffer_store_dwordx4 v[196:199], v10, s[16:19], s37 offen
    v_cvt_pk_bf16_f32 v200, v72, v73
    v_cvt_pk_bf16_f32 v201, v74, v75
    v_cvt_pk_bf16_f32 v202, v76, v77
    v_cvt_pk_bf16_f32 v203, v78, v79
    s_nop 1
    v_permlane32_swap_b32 v200, v202
    v_permlane32_swap_b32 v201, v203
    s_add_u32 s37, s36, 4096
    buffer_store_dwordx4 v[200:203], v10, s[16:19], s37 offen
    v_cvt_pk_bf16_f32 v196, v80, v81
    v_cvt_pk_bf16_f32 v197, v82, v83
    v_cvt_pk_bf16_f32 v198, v84, v85
    v_cvt_pk_bf16_f32 v199, v86, v87
    s_nop 1
    v_permlane32_swap_b32 v196, v198
    v_permlane32_swap_b32 v197, v199
    s_add_u32 s37, s36, 512
    buffer_store_dwordx4 v[196:199], v10, s[16:19], s37 offen
    v_cvt_pk_bf16_f32 v200, v88, v89
    v_cvt_pk_bf16_f32 v201, v90, v91
    v_cvt_pk_bf16_f32 v202, v92, v93
    v_cvt_pk_bf16_f32 v203, v94, v95
    s_nop 1
    v_permlane32_swap_b32 v200, v202
    v_permlane32_swap_b32 v201, v203
    s_add_u32 s37, s36, 4608
    buffer_store_dwordx4 v[200:203], v10, s[16:19], s37 offen
    v_cvt_pk_bf16_f32 v196, v96, v97
    v_cvt_pk_bf16_f32 v197, v98, v99
    v_cvt_pk_bf16_f32 v198, v100, v101
    v_cvt_pk_bf16_f32 v199, v102, v103
    s_nop 1
    v_permlane32_swap_b32 v196, v198
    v_permlane32_swap_b32 v197, v199
    s_add_u32 s37, s36, 8192
    buffer_store_dwordx4 v[196:199], v10, s[16:19], s37 offen
    v_cvt_pk_bf16_f32 v200, v104, v105
    v_cvt_pk_bf16_f32 v201, v106, v107
    v_cvt_pk_bf16_f32 v202, v108, v109
    v_cvt_pk_bf16_f32 v203, v110, v111
    s_nop 1
    v_permlane32_swap_b32 v200, v202
    v_permlane32_swap_b32 v201, v203
    s_add_u32 s37, s36, 12288
    buffer_store_dwordx4 v[200:203], v10, s[16:19], s37 offen
    v_cvt_pk_bf16_f32 v196, v112, v113
    v_cvt_pk_bf16_f32 v197, v114, v115
    v_cvt_pk_bf16_f32 v198, v116, v117
    v_cvt_pk_bf16_f32 v199, v118, v119
    s_nop 1
    v_permlane32_swap_b32 v196, v198
    v_permlane32_swap_b32 v197, v199
    s_add_u32 s37, s36, 8704
    buffer_store_dwordx4 v[196:199], v10, s[16:19], s37 offen
    v_cvt_pk_bf16_f32 v200, v120, v121
    v_cvt_pk_bf16_f32 v201, v122, v123
    v_cvt_pk_bf16_f32 v202, v124, v125
    v_cvt_pk_bf16_f32 v203, v126, v127
    s_nop 1
    v_permlane32_swap_b32 v200, v202
    v_permlane32_swap_b32 v201, v203
    s_add_u32 s37, s36, 12800
    buffer_store_dwordx4 v[200:203], v10, s[16:19], s37 offen
    v_cvt_pk_bf16_f32 v196, v128, v129
    v_cvt_pk_bf16_f32 v197, v130, v131
    v_cvt_pk_bf16_f32 v198, v132, v133
    v_cvt_pk_bf16_f32 v199, v134, v135
    s_nop 1
    v_permlane32_swap_b32 v196, v198
    v_permlane32_swap_b32 v197, v199
    s_add_u32 s37, s36, 16384
    buffer_store_dwordx4 v[196:199], v10, s[16:19], s37 offen
    v_cvt_pk_bf16_f32 v200, v136, v137
    v_cvt_pk_bf16_f32 v201, v138, v139
    v_cvt_pk_bf16_f32 v202, v140, v141
    v_cvt_pk_bf16_f32 v203, v142, v143
    s_nop 1
    v_permlane32_swap_b32 v200, v202
    v_permlane32_swap_b32 v201, v203
    s_add_u32 s37, s36, 20480
    buffer_store_dwordx4 v[200:203], v10, s[16:19], s37 offen
    v_cvt_pk_bf16_f32 v196, v144, v145
    v_cvt_pk_bf16_f32 v197, v146, v147
    v_cvt_pk_bf16_f32 v198, v148, v149
    v_cvt_pk_bf16_f32 v199, v150, v151
    s_nop 1
    v_permlane32_swap_b32 v196, v198
    v_permlane32_swap_b32 v197, v199
    s_add_u32 s37, s36, 16896
    buffer_store_dwordx4 v[196:199], v10, s[16:19], s37 offen
    v_cvt_pk_bf16_f32 v200, v152, v153
    v_cvt_pk_bf16_f32 v201, v154, v155
    v_cvt_pk_bf16_f32 v202, v156, v157
    v_cvt_pk_bf16_f32 v203, v158, v159
    s_nop 1
    v_permlane32_swap_b32 v200, v202
    v_permlane32_swap_b32 v201, v203
    s_add_u32 s37, s36, 20992
    buffer_store_dwordx4 v[200:203], v10, s[16:19], s37 offen
    v_cvt_pk_bf16_f32 v196, v160, v161
    v_cvt_pk_bf16_f32 v197, v162, v163
    v_cvt_pk_bf16_f32 v198, v164, v165
    v_cvt_pk_bf16_f32 v199, v166, v167
    s_nop 1
    v_permlane32_swap_b32 v196, v198
    v_permlane32_swap_b32 v197, v199
    s_add_u32 s37, s36, 24576
    buffer_store_dwordx4 v[196:199], v10, s[16:19], s37 offen
    v_cvt_pk_bf16_f32 v200, v168, v169
    v_cvt_pk_bf16_f32 v201, v170, v171
    v_cvt_pk_bf16_f32 v202, v172, v173
    v_cvt_pk_bf16_f32 v203, v174, v175
    s_nop 1
    v_permlane32_swap_b32 v200, v202
    v_permlane32_swap_b32 v201, v203
    s_add_u32 s37, s36, 28672
    buffer_store_dwordx4 v[200:203], v10, s[16:19], s37 offen
    v_cvt_pk_bf16_f32 v196, v176, v177
    v_cvt_pk_bf16_f32 v197, v178, v179
    v_cvt_pk_bf16_f32 v198, v180, v181
    v_cvt_pk_bf16_f32 v199, v182, v183
    s_nop 1
    v_permlane32_swap_b32 v196, v198
    v_permlane32_swap_b32 v197, v199
    s_add_u32 s37, s36, 25088
    buffer_store_dwordx4 v[196:199], v10, s[16:19], s37 offen
    v_cvt_pk_bf16_f32 v200, v184, v185
    v_cvt_pk_bf16_f32 v201, v186, v187
    v_cvt_pk_bf16_f32 v202, v188, v189
    v_cvt_pk_bf16_f32 v203, v190, v191
    s_nop 1
    v_permlane32_swap_b32 v200, v202
    v_permlane32_swap_b32 v201, v203
    s_add_u32 s37, s36, 29184
    buffer_store_dwordx4 v[200:203], v10, s[16:19], s37 offen
    s_endpgm
GA_EP_GELU:
    v_and_b32 v10, 31, v1
    v_lshlrev_b32 v10, 4, v10
    v_lshrrev_b32 v11, 5, v1
    v_lshl_add_u32 v10, v11, 11, v10
    s_mul_i32 s36, s43, s46
    s_mul_i32 s37, s47, 16
    s_add_u32 s37, s37, s45
    s_lshl_b32 s37, s37, 11
    s_add_u32 s36, s36, s37
    s_lshl_b32 s37, s48, 10
    s_add_u32 s36, s36, s37
    v_lshrrev_b32 v12, 5, v1
    v_lshlrev_b32 v12, 3, v12
    s_sub_u32 s37, s45, 512
    s_lshl_b32 s37, s37, 4
    s_mul_i32 s35, s47, 256
    s_add_u32 s37, s37, s35
    buffer_load_dwordx2 v[208:209], v12, s[20:23], s37 offen offset:0
    buffer_load_dwordx2 v[210:211], v12, s[20:23], s37 offen offset:16
    buffer_load_dwordx2 v[212:213], v12, s[20:23], s37 offen offset:32
    buffer_load_dwordx2 v[214:215], v12, s[20:23], s37 offen offset:48
    buffer_load_dwordx2 v[216:217], v12, s[20:23], s37 offen offset:64
    buffer_load_dwordx2 v[218:219], v12, s[20:23], s37 offen offset:80
    buffer_load_dwordx2 v[220:221], v12, s[20:23], s37 offen offset:96
    buffer_load_dwordx2 v[222:223], v12, s[20:23], s37 offen offset:112
    buffer_load_dwordx2 v[224:225], v12, s[20:23], s37 offen offset:128
    buffer_load_dwordx2 v[226:227], v12, s[20:23], s37 offen offset:144
    buffer_load_dwordx2 v[228:229], v12, s[20:23], s37 offen offset:160
    buffer_load_dwordx2 v[230:231], v12, s[20:23], s37 offen offset:176
    buffer_load_dwordx2 v[232:233], v12, s[20:23], s37 offen offset:192
    buffer_load_dwordx2 v[234:235], v12, s[20:23], s37 offen offset:208
    buffer_load_dwordx2 v[236:237], v12, s[20:23], s37 offen offset:224
    buffer_load_dwordx2 v[238:239], v12, s[20:23], s37 offen offset:240
    s_mov_b32 s35, 0xbdd2d3e8
    v_mov_b32 v207, 0xc0135761
    s_waitcnt vmcnt(0)
    v_lshlrev_b32 v204, 16, v208
    v_and_b32 v205, 0xffff0000, v208
    v_lshlrev_b32 v206, 16, v209
    v_and_b32 v195, 0xffff0000, v209
    v_add_f32 v64, v64, v204
    v_add_f32 v65, v65, v205
    v_add_f32 v66, v66, v206
    v_add_f32 v67, v67, v195
    v_mul_f32 v192, v64, v64
    v_mul_f32 v193, v65, v65
    v_mul_f32 v194, v66, v66
    v_mul_f32 v195, v67, v67
    v_fma_f32 v192, v192, s35, v207
    v_fma_f32 v193, v193, s35, v207
    v_fma_f32 v194, v194, s35, v207
    v_fma_f32 v195, v195, s35, v207
    v_mul_f32 v192, v192, v64
    v_mul_f32 v193, v193, v65
    v_mul_f32 v194, v194, v66
    v_mul_f32 v195, v195, v67
    v_exp_f32 v192, v192
    v_exp_f32 v193, v193
    v_exp_f32 v194, v194
    v_exp_f32 v195, v195
    v_add_f32 v192, 1.0, v192
    v_add_f32 v193, 1.0, v193
    v_add_f32 v194, 1.0, v194
    v_add_f32 v195, 1.0, v195
    v_rcp_f32 v192, v192
    v_rcp_f32 v193, v193
    v_rcp_f32 v194, v194
    v_rcp_f32 v195, v195
    v_mul_f32 v64, v64, v192
    v_mul_f32 v65, v65, v193
    v_mul_f32 v66, v66, v194
    v_mul_f32 v67, v67, v195
    v_cvt_pk_bf16_f32 v196, v64, v65
    v_cvt_pk_bf16_f32 v197, v66, v67
    v_lshlrev_b32 v204, 16, v210
    v_and_b32 v205, 0xffff0000, v210
    v_lshlrev_b32 v206, 16, v211
    v_and_b32 v195, 0xffff0000, v211
    v_add_f32 v68, v68, v204
    v_add_f32 v69, v69, v205
    v_add_f32 v70, v70, v206
    v_add_f32 v71, v71, v195
    v_mul_f32 v192, v68, v68
    v_mul_f32 v193, v69, v69
    v_mul_f32 v194, v70, v70
    v_mul_f32 v195, v71, v71
    v_fma_f32 v192, v192, s35, v207
    v_fma_f32 v193, v193, s35, v207
    v_fma_f32 v194, v194, s35, v207
    v_fma_f32 v195, v195, s35, v207
    v_mul_f32 v192, v192, v68
    v_mul_f32 v193, v193, v69
    v_mul_f32 v194, v194, v70
    v_mul_f32 v195, v195, v71
    v_exp_f32 v192, v192
    v_exp_f32 v193, v193
    v_exp_f32 v194, v194
    v_exp_f32 v195, v195
    v_add_f32 v192, 1.0, v192
    v_add_f32 v193, 1.0, v193
    v_add_f32 v194, 1.0, v194
    v_add_f32 v195, 1.0, v195
    v_rcp_f32 v192, v192
    v_rcp_f32 v193, v193
    v_rcp_f32 v194, v194
    v_rcp_f32 v195, v195
    v_mul_f32 v68, v68, v192
    v_mul_f32 v69, v69, v193
    v_mul_f32 v70, v70, v194
    v_mul_f32 v71, v71, v195
    v_cvt_pk_bf16_f32 v198, v68, v69
    v_cvt_pk_bf16_f32 v199, v70, v71
    s_nop 1
    v_permlane32_swap_b32 v196, v198
    v_permlane32_swap_b32 v197, v199
    s_add_u32 s37, s36, 0
    buffer_store_dwordx4 v[196:199], v10, s[16:19], s37 offen
    v_lshlrev_b32 v204, 16, v212
    v_and_b32 v205, 0xffff0000, v212
    v_lshlrev_b32 v206, 16, v213
    v_and_b32 v195, 0xffff0000, v213
    v_add_f32 v72, v72, v204
    v_add_f32 v73, v73, v205
    v_add_f32 v74, v74, v206
    v_add_f32 v75, v75, v195
    v_mul_f32 v192, v72, v72
    v_mul_f32 v193, v73, v73
    v_mul_f32 v194, v74, v74
    v_mul_f32 v195, v75, v75
    v_fma_f32 v192, v192, s35, v207
    v_fma_f32 v193, v193, s35, v207
    v_fma_f32 v194, v194, s35, v207
    v_fma_f32 v195, v195, s35, v207
    v_mul_f32 v192, v192, v72
    v_mul_f32 v193, v193, v73
    v_mul_f32 v194, v194, v74
    v_mul_f32 v195, v195, v75
    v_exp_f32 v192, v192
    v_exp_f32 v193, v193
    v_exp_f32 v194, v194
    v_exp_f32 v195, v195
    v_add_f32 v192, 1.0, v192
    v_add_f32 v193, 1.0, v193
    v_add_f32 v194, 1.0, v194
    v_add_f32 v195, 1.0, v195
    v_rcp_f32 v192, v192
    v_rcp_f32 v193, v193
    v_rcp_f32 v194, v194
    v_rcp_f32 v195, v195
    v_mul_f32 v72, v72, v192
    v_mul_f32 v73, v73, v193
    v_mul_f32 v74, v74, v194
    v_mul_f32 v75, v75, v195
    v_cvt_pk_bf16_f32 v200, v72, v73
    v_cvt_pk_bf16_f32 v201, v74, v75
    v_lshlrev_b32 v204, 16, v214
    v_and_b32 v205, 0xffff0000, v214
    v_lshlrev_b32 v206, 16, v215
    v_and_b32 v195, 0xffff0000, v215
    v_add_f32 v76, v76, v204
    v_add_f32 v77, v77, v205
    v_add_f32 v78, v78, v206
    v_add_f32 v79, v79, v195
    v_mul_f32 v192, v76, v76
    v_mul_f32 v193, v77, v77
    v_mul_f32 v194, v78, v78
    v_mul_f32 v195, v79, v79
    v_fma_f32 v192, v192, s35, v207
    v_fma_f32 v193, v193, s35, v207
    v_fma_f32 v194, v194, s35, v207
    v_fma_f32 v195, v195, s35, v207
    v_mul_f32 v192, v192, v76
    v_mul_f32 v193, v193, v77
    v_mul_f32 v194, v194, v78
    v_mul_f32 v195, v195, v79
    v_exp_f32 v192, v192
    v_exp_f32 v193, v193
    v_exp_f32 v194, v194
    v_exp_f32 v195, v195
    v_add_f32 v192, 1.0, v192
    v_add_f32 v193, 1.0, v193
    v_add_f32 v194, 1.0, v194
    v_add_f32 v195, 1.0, v195
    v_rcp_f32 v192, v192
    v_rcp_f32 v193, v193
    v_rcp_f32 v194, v194
    v_rcp_f32 v195, v195
    v_mul_f32 v76, v76, v192
    v_mul_f32 v77, v77, v193
    v_mul_f32 v78, v78, v194
    v_mul_f32 v79, v79, v195
    v_cvt_pk_bf16_f32 v202, v76, v77
    v_cvt_pk_bf16_f32 v203, v78, v79
    s_nop 1
    v_permlane32_swap_b32 v200, v202
    v_permlane32_swap_b32 v201, v203
    s_add_u32 s37, s36, 4096
    buffer_store_dwordx4 v[200:203], v10, s[16:19], s37 offen
    v_lshlrev_b32 v204, 16, v208
    v_and_b32 v205, 0xffff0000, v208
    v_lshlrev_b32 v206, 16, v209
    v_and_b32 v195, 0xffff0000, v209
    v_add_f32 v80, v80, v204
    v_add_f32 v81, v81, v205
    v_add_f32 v82, v82, v206
    v_add_f32 v83, v83, v195
    v_mul_f32 v192, v80, v80
    v_mul_f32 v193, v81, v81
    v_mul_f32 v194, v82, v82
    v_mul_f32 v195, v83, v83
    v_fma_f32 v192, v192, s35, v207
    v_fma_f32 v193, v193, s35, v207
    v_fma_f32 v194, v194, s35, v207
    v_fma_f32 v195, v195, s35, v207
    v_mul_f32 v192, v192, v80
    v_mul_f32 v193, v193, v81
    v_mul_f32 v194, v194, v82
    v_mul_f32 v195, v195, v83
    v_exp_f32 v192, v192
    v_exp_f32 v193, v193
    v_exp_f32 v194, v194
    v_exp_f32 v195, v195
    v_add_f32 v192, 1.0, v192
    v_add_f32 v193, 1.0, v193
    v_add_f32 v194, 1.0, v194
    v_add_f32 v195, 1.0, v195
    v_rcp_f32 v192, v192
    v_rcp_f32 v193, v193
    v_rcp_f32 v194, v194
    v_rcp_f32 v195, v195
    v_mul_f32 v80, v80, v192
    v_mul_f32 v81, v81, v193
    v_mul_f32 v82, v82, v194
    v_mul_f32 v83, v83, v195
    v_cvt_pk_bf16_f32 v196, v80, v81
    v_cvt_pk_bf16_f32 v197, v82, v83
    v_lshlrev_b32 v204, 16, v210
    v_and_b32 v205, 0xffff0000, v210
    v_lshlrev_b32 v206, 16, v211
    v_and_b32 v195, 0xffff0000, v211
    v_add_f32 v84, v84, v204
    v_add_f32 v85, v85, v205
    v_add_f32 v86, v86, v206
    v_add_f32 v87, v87, v195
    v_mul_f32 v192, v84, v84
    v_mul_f32 v193, v85, v85
    v_mul_f32 v194, v86, v86
    v_mul_f32 v195, v87, v87
    v_fma_f32 v192, v192, s35, v207
    v_fma_f32 v193, v193, s35, v207
    v_fma_f32 v194, v194, s35, v207
    v_fma_f32 v195, v195, s35, v207
    v_mul_f32 v192, v192, v84
    v_mul_f32 v193, v193, v85
    v_mul_f32 v194, v194, v86
    v_mul_f32 v195, v195, v87
    v_exp_f32 v192, v192
    v_exp_f32 v193, v193
    v_exp_f32 v194, v194
    v_exp_f32 v195, v195
    v_add_f32 v192, 1.0, v192
    v_add_f32 v193, 1.0, v193
    v_add_f32 v194, 1.0, v194
    v_add_f32 v195, 1.0, v195
    v_rcp_f32 v192, v192
    v_rcp_f32 v193, v193
    v_rcp_f32 v194, v194
    v_rcp_f32 v195, v195
    v_mul_f32 v84, v84, v192
    v_mul_f32 v85, v85, v193
    v_mul_f32 v86, v86, v194
    v_mul_f32 v87, v87, v195
    v_cvt_pk_bf16_f32 v198, v84, v85
    v_cvt_pk_bf16_f32 v199, v86, v87
    s_nop 1
    v_permlane32_swap_b32 v196, v198
    v_permlane32_swap_b32 v197, v199
    s_add_u32 s37, s36, 512
    buffer_store_dwordx4 v[196:199], v10, s[16:19], s37 offen
    v_lshlrev_b32 v204, 16, v212
    v_and_b32 v205, 0xffff0000, v212
    v_lshlrev_b32 v206, 16, v213
    v_and_b32 v195, 0xffff0000, v213
    v_add_f32 v88, v88, v204
    v_add_f32 v89, v89, v205
    v_add_f32 v90, v90, v206
    v_add_f32 v91, v91, v195
    v_mul_f32 v192, v88, v88
    v_mul_f32 v193, v89, v89
    v_mul_f32 v194, v90, v90
    v_mul_f32 v195, v91, v91
    v_fma_f32 v192, v192, s35, v207
    v_fma_f32 v193, v193, s35, v207
    v_fma_f32 v194, v194, s35, v207
    v_fma_f32 v195, v195, s35, v207
    v_mul_f32 v192, v192, v88
    v_mul_f32 v193, v193, v89
    v_mul_f32 v194, v194, v90
    v_mul_f32 v195, v195, v91
    v_exp_f32 v192, v192
    v_exp_f32 v193, v193
    v_exp_f32 v194, v194
    v_exp_f32 v195, v195
    v_add_f32 v192, 1.0, v192
    v_add_f32 v193, 1.0, v193
    v_add_f32 v194, 1.0, v194
    v_add_f32 v195, 1.0, v195
    v_rcp_f32 v192, v192
    v_rcp_f32 v193, v193
    v_rcp_f32 v194, v194
    v_rcp_f32 v195, v195
    v_mul_f32 v88, v88, v192
    v_mul_f32 v89, v89, v193
    v_mul_f32 v90, v90, v194
    v_mul_f32 v91, v91, v195
    v_cvt_pk_bf16_f32 v200, v88, v89
    v_cvt_pk_bf16_f32 v201, v90, v91
    v_lshlrev_b32 v204, 16, v214
    v_and_b32 v205, 0xffff0000, v214
    v_lshlrev_b32 v206, 16, v215
    v_and_b32 v195, 0xffff0000, v215
    v_add_f32 v92, v92, v204
    v_add_f32 v93, v93, v205
    v_add_f32 v94, v94, v206
    v_add_f32 v95, v95, v195
    v_mul_f32 v192, v92, v92
    v_mul_f32 v193, v93, v93
    v_mul_f32 v194, v94, v94
    v_mul_f32 v195, v95, v95
    v_fma_f32 v192, v192, s35, v207
    v_fma_f32 v193, v193, s35, v207
    v_fma_f32 v194, v194, s35, v207
    v_fma_f32 v195, v195, s35, v207
    v_mul_f32 v192, v192, v92
    v_mul_f32 v193, v193, v93
    v_mul_f32 v194, v194, v94
    v_mul_f32 v195, v195, v95
    v_exp_f32 v192, v192
    v_exp_f32 v193, v193
    v_exp_f32 v194, v194
    v_exp_f32 v195, v195
    v_add_f32 v192, 1.0, v192
    v_add_f32 v193, 1.0, v193
    v_add_f32 v194, 1.0, v194
    v_add_f32 v195, 1.0, v195
    v_rcp_f32 v192, v192
    v_rcp_f32 v193, v193
    v_rcp_f32 v194, v194
    v_rcp_f32 v195, v195
    v_mul_f32 v92, v92, v192
    v_mul_f32 v93, v93, v193
    v_mul_f32 v94, v94, v194
    v_mul_f32 v95, v95, v195
    v_cvt_pk_bf16_f32 v202, v92, v93
    v_cvt_pk_bf16_f32 v203, v94, v95
    s_nop 1
    v_permlane32_swap_b32 v200, v202
    v_permlane32_swap_b32 v201, v203
    s_add_u32 s37, s36, 4608
    buffer_store_dwordx4 v[200:203], v10, s[16:19], s37 offen
    v_lshlrev_b32 v204, 16, v216
    v_and_b32 v205, 0xffff0000, v216
    v_lshlrev_b32 v206, 16, v217
    v_and_b32 v195, 0xffff0000, v217
    v_add_f32 v96, v96, v204
    v_add_f32 v97, v97, v205
    v_add_f32 v98, v98, v206
    v_add_f32 v99, v99, v195
    v_mul_f32 v192, v96, v96
    v_mul_f32 v193, v97, v97
    v_mul_f32 v194, v98, v98
    v_mul_f32 v195, v99, v99
    v_fma_f32 v192, v192, s35, v207
    v_fma_f32 v193, v193, s35, v207
    v_fma_f32 v194, v194, s35, v207
    v_fma_f32 v195, v195, s35, v207
    v_mul_f32 v192, v192, v96
    v_mul_f32 v193, v193, v97
    v_mul_f32 v194, v194, v98
    v_mul_f32 v195, v195, v99
    v_exp_f32 v192, v192
    v_exp_f32 v193, v193
    v_exp_f32 v194, v194
    v_exp_f32 v195, v195
    v_add_f32 v192, 1.0, v192
    v_add_f32 v193, 1.0, v193
    v_add_f32 v194, 1.0, v194
    v_add_f32 v195, 1.0, v195
    v_rcp_f32 v192, v192
    v_rcp_f32 v193, v193
    v_rcp_f32 v194, v194
    v_rcp_f32 v195, v195
    v_mul_f32 v96, v96, v192
    v_mul_f32 v97, v97, v193
    v_mul_f32 v98, v98, v194
    v_mul_f32 v99, v99, v195
    v_cvt_pk_bf16_f32 v196, v96, v97
    v_cvt_pk_bf16_f32 v197, v98, v99
    v_lshlrev_b32 v204, 16, v218
    v_and_b32 v205, 0xffff0000, v218
    v_lshlrev_b32 v206, 16, v219
    v_and_b32 v195, 0xffff0000, v219
    v_add_f32 v100, v100, v204
    v_add_f32 v101, v101, v205
    v_add_f32 v102, v102, v206
    v_add_f32 v103, v103, v195
    v_mul_f32 v192, v100, v100
    v_mul_f32 v193, v101, v101
    v_mul_f32 v194, v102, v102
    v_mul_f32 v195, v103, v103
    v_fma_f32 v192, v192, s35, v207
    v_fma_f32 v193, v193, s35, v207
    v_fma_f32 v194, v194, s35, v207
    v_fma_f32 v195, v195, s35, v207
    v_mul_f32 v192, v192, v100
    v_mul_f32 v193, v193, v101
    v_mul_f32 v194, v194, v102
    v_mul_f32 v195, v195, v103
    v_exp_f32 v192, v192
    v_exp_f32 v193, v193
    v_exp_f32 v194, v194
    v_exp_f32 v195, v195
    v_add_f32 v192, 1.0, v192
    v_add_f32 v193, 1.0, v193
    v_add_f32 v194, 1.0, v194
    v_add_f32 v195, 1.0, v195
    v_rcp_f32 v192, v192
    v_rcp_f32 v193, v193
    v_rcp_f32 v194, v194
    v_rcp_f32 v195, v195
    v_mul_f32 v100, v100, v192
    v_mul_f32 v101, v101, v193
    v_mul_f32 v102, v102, v194
    v_mul_f32 v103, v103, v195
    v_cvt_pk_bf16_f32 v198, v100, v101
    v_cvt_pk_bf16_f32 v199, v102, v103
    s_nop 1
    v_permlane32_swap_b32 v196, v198
    v_permlane32_swap_b32 v197, v199
    s_add_u32 s37, s36, 8192
    buffer_store_dwordx4 v[196:199], v10, s[16:19], s37 offen
    v_lshlrev_b32 v204, 16, v220
    v_and_b32 v205, 0xffff0000, v220
    v_lshlrev_b32 v206, 16, v221
    v_and_b32 v195, 0xffff0000, v221
    v_add_f32 v104, v104, v204
    v_add_f32 v105, v105, v205
    v_add_f32 v106, v106, v206
    v_add_f32 v107, v107, v195
    v_mul_f32 v192, v104, v104
    v_mul_f32 v193, v105, v105
    v_mul_f32 v194, v106, v106
    v_mul_f32 v195, v107, v107
    v_fma_f32 v192, v192, s35, v207
    v_fma_f32 v193, v193, s35, v207
    v_fma_f32 v194, v194, s35, v207
    v_fma_f32 v195, v195, s35, v207
    v_mul_f32 v192, v192, v104
    v_mul_f32 v193, v193, v105
    v_mul_f32 v194, v194, v106
    v_mul_f32 v195, v195, v107
    v_exp_f32 v192, v192
    v_exp_f32 v193, v193
    v_exp_f32 v194, v194
    v_exp_f32 v195, v195
    v_add_f32 v192, 1.0, v192
    v_add_f32 v193, 1.0, v193
    v_add_f32 v194, 1.0, v194
    v_add_f32 v195, 1.0, v195
    v_rcp_f32 v192, v192
    v_rcp_f32 v193, v193
    v_rcp_f32 v194, v194
    v_rcp_f32 v195, v195
    v_mul_f32 v104, v104, v192
    v_mul_f32 v105, v105, v193
    v_mul_f32 v106, v106, v194
    v_mul_f32 v107, v107, v195
    v_cvt_pk_bf16_f32 v200, v104, v105
    v_cvt_pk_bf16_f32 v201, v106, v107
    v_lshlrev_b32 v204, 16, v222
    v_and_b32 v205, 0xffff0000, v222
    v_lshlrev_b32 v206, 16, v223
    v_and_b32 v195, 0xffff0000, v223
    v_add_f32 v108, v108, v204
    v_add_f32 v109, v109, v205
    v_add_f32 v110, v110, v206
    v_add_f32 v111, v111, v195
    v_mul_f32 v192, v108, v108
    v_mul_f32 v193, v109, v109
    v_mul_f32 v194, v110, v110
    v_mul_f32 v195, v111, v111
    v_fma_f32 v192, v192, s35, v207
    v_fma_f32 v193, v193, s35, v207
    v_fma_f32 v194, v194, s35, v207
    v_fma_f32 v195, v195, s35, v207
    v_mul_f32 v192, v192, v108
    v_mul_f32 v193, v193, v109
    v_mul_f32 v194, v194, v110
    v_mul_f32 v195, v195, v111
    v_exp_f32 v192, v192
    v_exp_f32 v193, v193
    v_exp_f32 v194, v194
    v_exp_f32 v195, v195
    v_add_f32 v192, 1.0, v192
    v_add_f32 v193, 1.0, v193
    v_add_f32 v194, 1.0, v194
    v_add_f32 v195, 1.0, v195
    v_rcp_f32 v192, v192
    v_rcp_f32 v193, v193
    v_rcp_f32 v194, v194
    v_rcp_f32 v195, v195
    v_mul_f32 v108, v108, v192
    v_mul_f32 v109, v109, v193
    v_mul_f32 v110, v110, v194
    v_mul_f32 v111, v111, v195
    v_cvt_pk_bf16_f32 v202, v108, v109
    v_cvt_pk_bf16_f32 v203, v110, v111
    s_nop 1
    v_permlane32_swap_b32 v200, v202
    v_permlane32_swap_b32 v201, v203
    s_add_u32 s37, s36, 12288
    buffer_store_dwordx4 v[200:203], v10, s[16:19], s37 offen
    v_lshlrev_b32 v204, 16, v216
    v_and_b32 v205, 0xffff0000, v216
    v_lshlrev_b32 v206, 16, v217
    v_and_b32 v195, 0xffff0000, v217
    v_add_f32 v112, v112, v204
    v_add_f32 v113, v113, v205
    v_add_f32 v114, v114, v206
    v_add_f32 v115, v115, v195
    v_mul_f32 v192, v112, v112
    v_mul_f32 v193, v113, v113
    v_mul_f32 v194, v114, v114
    v_mul_f32 v195, v115, v115
    v_fma_f32 v192, v192, s35, v207
    v_fma_f32 v193, v193, s35, v207
    v_fma_f32 v194, v194, s35, v207
    v_fma_f32 v195, v195, s35, v207
    v_mul_f32 v192, v192, v112
    v_mul_f32 v193, v193, v113
    v_mul_f32 v194, v194, v114
    v_mul_f32 v195, v195, v115
    v_exp_f32 v192, v192
    v_exp_f32 v193, v193
    v_exp_f32 v194, v194
    v_exp_f32 v195, v195
    v_add_f32 v192, 1.0, v192
    v_add_f32 v193, 1.0, v193
    v_add_f32 v194, 1.0, v194
    v_add_f32 v195, 1.0, v195
    v_rcp_f32 v192, v192
    v_rcp_f32 v193, v193
    v_rcp_f32 v194, v194
    v_rcp_f32 v195, v195
    v_mul_f32 v112, v112, v192
    v_mul_f32 v113, v113, v193
    v_mul_f32 v114, v114, v194
    v_mul_f32 v115, v115, v195
    v_cvt_pk_bf16_f32 v196, v112, v113
    v_cvt_pk_bf16_f32 v197, v114, v115
    v_lshlrev_b32 v204, 16, v218
    v_and_b32 v205, 0xffff0000, v218
    v_lshlrev_b32 v206, 16, v219
    v_and_b32 v195, 0xffff0000, v219
    v_add_f32 v116, v116, v204
    v_add_f32 v117, v117, v205
    v_add_f32 v118, v118, v206
    v_add_f32 v119, v119, v195
    v_mul_f32 v192, v116, v116
    v_mul_f32 v193, v117, v117
    v_mul_f32 v194, v118, v118
    v_mul_f32 v195, v119, v119
    v_fma_f32 v192, v192, s35, v207
    v_fma_f32 v193, v193, s35, v207
    v_fma_f32 v194, v194, s35, v207
    v_fma_f32 v195, v195, s35, v207
    v_mul_f32 v192, v192, v116
    v_mul_f32 v193, v193, v117
    v_mul_f32 v194, v194, v118
    v_mul_f32 v195, v195, v119
    v_exp_f32 v192, v192
    v_exp_f32 v193, v193
    v_exp_f32 v194, v194
    v_exp_f32 v195, v195
    v_add_f32 v192, 1.0, v192
    v_add_f32 v193, 1.0, v193
    v_add_f32 v194, 1.0, v194
    v_add_f32 v195, 1.0, v195
    v_rcp_f32 v192, v192
    v_rcp_f32 v193, v193
    v_rcp_f32 v194, v194
    v_rcp_f32 v195, v195
    v_mul_f32 v116, v116, v192
    v_mul_f32 v117, v117, v193
    v_mul_f32 v118, v118, v194
    v_mul_f32 v119, v119, v195
    v_cvt_pk_bf16_f32 v198, v116, v117
    v_cvt_pk_bf16_f32 v199, v118, v119
    s_nop 1
    v_permlane32_swap_b32 v196, v198
    v_permlane32_swap_b32 v197, v199
    s_add_u32 s37, s36, 8704
    buffer_store_dwordx4 v[196:199], v10, s[16:19], s37 offen
    v_lshlrev_b32 v204, 16, v220
    v_and_b32 v205, 0xffff0000, v220
    v_lshlrev_b32 v206, 16, v221
    v_and_b32 v195, 0xffff0000, v221
    v_add_f32 v120, v120, v204
    v_add_f32 v121, v121, v205
    v_add_f32 v122, v122, v206
    v_add_f32 v123, v123, v195
    v_mul_f32 v192, v120, v120
    v_mul_f32 v193, v121, v121
    v_mul_f32 v194, v122, v122
    v_mul_f32 v195, v123, v123
    v_fma_f32 v192, v192, s35, v207
    v_fma_f32 v193, v193, s35, v207
    v_fma_f32 v194, v194, s35, v207
    v_fma_f32 v195, v195, s35, v207
    v_mul_f32 v192, v192, v120
    v_mul_f32 v193, v193, v121
    v_mul_f32 v194, v194, v122
    v_mul_f32 v195, v195, v123
    v_exp_f32 v192, v192
    v_exp_f32 v193, v193
    v_exp_f32 v194, v194
    v_exp_f32 v195, v195
    v_add_f32 v192, 1.0, v192
    v_add_f32 v193, 1.0, v193
    v_add_f32 v194, 1.0, v194
    v_add_f32 v195, 1.0, v195
    v_rcp_f32 v192, v192
    v_rcp_f32 v193, v193
    v_rcp_f32 v194, v194
    v_rcp_f32 v195, v195
    v_mul_f32 v120, v120, v192
    v_mul_f32 v121, v121, v193
    v_mul_f32 v122, v122, v194
    v_mul_f32 v123, v123, v195
    v_cvt_pk_bf16_f32 v200, v120, v121
    v_cvt_pk_bf16_f32 v201, v122, v123
    v_lshlrev_b32 v204, 16, v222
    v_and_b32 v205, 0xffff0000, v222
    v_lshlrev_b32 v206, 16, v223
    v_and_b32 v195, 0xffff0000, v223
    v_add_f32 v124, v124, v204
    v_add_f32 v125, v125, v205
    v_add_f32 v126, v126, v206
    v_add_f32 v127, v127, v195
    v_mul_f32 v192, v124, v124
    v_mul_f32 v193, v125, v125
    v_mul_f32 v194, v126, v126
    v_mul_f32 v195, v127, v127
    v_fma_f32 v192, v192, s35, v207
    v_fma_f32 v193, v193, s35, v207
    v_fma_f32 v194, v194, s35, v207
    v_fma_f32 v195, v195, s35, v207
    v_mul_f32 v192, v192, v124
    v_mul_f32 v193, v193, v125
    v_mul_f32 v194, v194, v126
    v_mul_f32 v195, v195, v127
    v_exp_f32 v192, v192
    v_exp_f32 v193, v193
    v_exp_f32 v194, v194
    v_exp_f32 v195, v195
    v_add_f32 v192, 1.0, v192
    v_add_f32 v193, 1.0, v193
    v_add_f32 v194, 1.0, v194
    v_add_f32 v195, 1.0, v195
    v_rcp_f32 v192, v192
    v_rcp_f32 v193, v193
    v_rcp_f32 v194, v194
    v_rcp_f32 v195, v195
    v_mul_f32 v124, v124, v192
    v_mul_f32 v125, v125, v193
    v_mul_f32 v126, v126, v194
    v_mul_f32 v127, v127, v195
    v_cvt_pk_bf16_f32 v202, v124, v125
    v_cvt_pk_bf16_f32 v203, v126, v127
    s_nop 1
    v_permlane32_swap_b32 v200, v202
    v_permlane32_swap_b32 v201, v203
    s_add_u32 s37, s36, 12800
    buffer_store_dwordx4 v[200:203], v10, s[16:19], s37 offen
    v_lshlrev_b32 v204, 16, v224
    v_and_b32 v205, 0xffff0000, v224
    v_lshlrev_b32 v206, 16, v225
    v_and_b32 v195, 0xffff0000, v225
    v_add_f32 v128, v128, v204
    v_add_f32 v129, v129, v205
    v_add_f32 v130, v130, v206
    v_add_f32 v131, v131, v195
    v_mul_f32 v192, v128, v128
    v_mul_f32 v193, v129, v129
    v_mul_f32 v194, v130, v130
    v_mul_f32 v195, v131, v131
    v_fma_f32 v192, v192, s35, v207
    v_fma_f32 v193, v193, s35, v207
    v_fma_f32 v194, v194, s35, v207
    v_fma_f32 v195, v195, s35, v207
    v_mul_f32 v192, v192, v128
    v_mul_f32 v193, v193, v129
    v_mul_f32 v194, v194, v130
    v_mul_f32 v195, v195, v131
    v_exp_f32 v192, v192
    v_exp_f32 v193, v193
    v_exp_f32 v194, v194
    v_exp_f32 v195, v195
    v_add_f32 v192, 1.0, v192
    v_add_f32 v193, 1.0, v193
    v_add_f32 v194, 1.0, v194
    v_add_f32 v195, 1.0, v195
    v_rcp_f32 v192, v192
    v_rcp_f32 v193, v193
    v_rcp_f32 v194, v194
    v_rcp_f32 v195, v195
    v_mul_f32 v128, v128, v192
    v_mul_f32 v129, v129, v193
    v_mul_f32 v130, v130, v194
    v_mul_f32 v131, v131, v195
    v_cvt_pk_bf16_f32 v196, v128, v129
    v_cvt_pk_bf16_f32 v197, v130, v131
    v_lshlrev_b32 v204, 16, v226
    v_and_b32 v205, 0xffff0000, v226
    v_lshlrev_b32 v206, 16, v227
    v_and_b32 v195, 0xffff0000, v227
    v_add_f32 v132, v132, v204
    v_add_f32 v133, v133, v205
    v_add_f32 v134, v134, v206
    v_add_f32 v135, v135, v195
    v_mul_f32 v192, v132, v132
    v_mul_f32 v193, v133, v133
    v_mul_f32 v194, v134, v134
    v_mul_f32 v195, v135, v135
    v_fma_f32 v192, v192, s35, v207
    v_fma_f32 v193, v193, s35, v207
    v_fma_f32 v194, v194, s35, v207
    v_fma_f32 v195, v195, s35, v207
    v_mul_f32 v192, v192, v132
    v_mul_f32 v193, v193, v133
    v_mul_f32 v194, v194, v134
    v_mul_f32 v195, v195, v135
    v_exp_f32 v192, v192
    v_exp_f32 v193, v193
    v_exp_f32 v194, v194
    v_exp_f32 v195, v195
    v_add_f32 v192, 1.0, v192
    v_add_f32 v193, 1.0, v193
    v_add_f32 v194, 1.0, v194
    v_add_f32 v195, 1.0, v195
    v_rcp_f32 v192, v192
    v_rcp_f32 v193, v193
    v_rcp_f32 v194, v194
    v_rcp_f32 v195, v195
    v_mul_f32 v132, v132, v192
    v_mul_f32 v133, v133, v193
    v_mul_f32 v134, v134, v194
    v_mul_f32 v135, v135, v195
    v_cvt_pk_bf16_f32 v198, v132, v133
    v_cvt_pk_bf16_f32 v199, v134, v135
    s_nop 1
    v_permlane32_swap_b32 v196, v198
    v_permlane32_swap_b32 v197, v199
    s_add_u32 s37, s36, 16384
    buffer_store_dwordx4 v[196:199], v10, s[16:19], s37 offen
    v_lshlrev_b32 v204, 16, v228
    v_and_b32 v205, 0xffff0000, v228
    v_lshlrev_b32 v206, 16, v229
    v_and_b32 v195, 0xffff0000, v229
    v_add_f32 v136, v136, v204
    v_add_f32 v137, v137, v205
    v_add_f32 v138, v138, v206
    v_add_f32 v139, v139, v195
    v_mul_f32 v192, v136, v136
    v_mul_f32 v193, v137, v137
    v_mul_f32 v194, v138, v138
    v_mul_f32 v195, v139, v139
    v_fma_f32 v192, v192, s35, v207
    v_fma_f32 v193, v193, s35, v207
    v_fma_f32 v194, v194, s35, v207
    v_fma_f32 v195, v195, s35, v207
    v_mul_f32 v192, v192, v136
    v_mul_f32 v193, v193, v137
    v_mul_f32 v194, v194, v138
    v_mul_f32 v195, v195, v139
    v_exp_f32 v192, v192
    v_exp_f32 v193, v193
    v_exp_f32 v194, v194
    v_exp_f32 v195, v195
    v_add_f32 v192, 1.0, v192
    v_add_f32 v193, 1.0, v193
    v_add_f32 v194, 1.0, v194
    v_add_f32 v195, 1.0, v195
    v_rcp_f32 v192, v192
    v_rcp_f32 v193, v193
    v_rcp_f32 v194, v194
    v_rcp_f32 v195, v195
    v_mul_f32 v136, v136, v192
    v_mul_f32 v137, v137, v193
    v_mul_f32 v138, v138, v194
    v_mul_f32 v139, v139, v195
    v_cvt_pk_bf16_f32 v200, v136, v137
    v_cvt_pk_bf16_f32 v201, v138, v139
    v_lshlrev_b32 v204, 16, v230
    v_and_b32 v205, 0xffff0000, v230
    v_lshlrev_b32 v206, 16, v231
    v_and_b32 v195, 0xffff0000, v231
    v_add_f32 v140, v140, v204
    v_add_f32 v141, v141, v205
    v_add_f32 v142, v142, v206
    v_add_f32 v143, v143, v195
    v_mul_f32 v192, v140, v140
    v_mul_f32 v193, v141, v141
    v_mul_f32 v194, v142, v142
    v_mul_f32 v195, v143, v143
    v_fma_f32 v192, v192, s35, v207
    v_fma_f32 v193, v193, s35, v207
    v_fma_f32 v194, v194, s35, v207
    v_fma_f32 v195, v195, s35, v207
    v_mul_f32 v192, v192, v140
    v_mul_f32 v193, v193, v141
    v_mul_f32 v194, v194, v142
    v_mul_f32 v195, v195, v143
    v_exp_f32 v192, v192
    v_exp_f32 v193, v193
    v_exp_f32 v194, v194
    v_exp_f32 v195, v195
    v_add_f32 v192, 1.0, v192
    v_add_f32 v193, 1.0, v193
    v_add_f32 v194, 1.0, v194
    v_add_f32 v195, 1.0, v195
    v_rcp_f32 v192, v192
    v_rcp_f32 v193, v193
    v_rcp_f32 v194, v194
    v_rcp_f32 v195, v195
    v_mul_f32 v140, v140, v192
    v_mul_f32 v141, v141, v193
    v_mul_f32 v142, v142, v194
    v_mul_f32 v143, v143, v195
    v_cvt_pk_bf16_f32 v202, v140, v141
    v_cvt_pk_bf16_f32 v203, v142, v143
    s_nop 1
    v_permlane32_swap_b32 v200, v202
    v_permlane32_swap_b32 v201, v203
    s_add_u32 s37, s36, 20480
    buffer_store_dwordx4 v[200:203], v10, s[16:19], s37 offen
    v_lshlrev_b32 v204, 16, v224
    v_and_b32 v205, 0xffff0000, v224
    v_lshlrev_b32 v206, 16, v225
    v_and_b32 v195, 0xffff0000, v225
    v_add_f32 v144, v144, v204
    v_add_f32 v145, v145, v205
    v_add_f32 v146, v146, v206
    v_add_f32 v147, v147, v195
    v_mul_f32 v192, v144, v144
    v_mul_f32 v193, v145, v145
    v_mul_f32 v194, v146, v146
    v_mul_f32 v195, v147, v147
    v_fma_f32 v192, v192, s35, v207
    v_fma_f32 v193, v193, s35, v207
    v_fma_f32 v194, v194, s35, v207
    v_fma_f32 v195, v195, s35, v207
    v_mul_f32 v192, v192, v144
    v_mul_f32 v193, v193, v145
    v_mul_f32 v194, v194, v146
    v_mul_f32 v195, v195, v147
    v_exp_f32 v192, v192
    v_exp_f32 v193, v193
    v_exp_f32 v194, v194
    v_exp_f32 v195, v195
    v_add_f32 v192, 1.0, v192
    v_add_f32 v193, 1.0, v193
    v_add_f32 v194, 1.0, v194
    v_add_f32 v195, 1.0, v195
    v_rcp_f32 v192, v192
    v_rcp_f32 v193, v193
    v_rcp_f32 v194, v194
    v_rcp_f32 v195, v195
    v_mul_f32 v144, v144, v192
    v_mul_f32 v145, v145, v193
    v_mul_f32 v146, v146, v194
    v_mul_f32 v147, v147, v195
    v_cvt_pk_bf16_f32 v196, v144, v145
    v_cvt_pk_bf16_f32 v197, v146, v147
    v_lshlrev_b32 v204, 16, v226
    v_and_b32 v205, 0xffff0000, v226
    v_lshlrev_b32 v206, 16, v227
    v_and_b32 v195, 0xffff0000, v227
    v_add_f32 v148, v148, v204
    v_add_f32 v149, v149, v205
    v_add_f32 v150, v150, v206
    v_add_f32 v151, v151, v195
    v_mul_f32 v192, v148, v148
    v_mul_f32 v193, v149, v149
    v_mul_f32 v194, v150, v150
    v_mul_f32 v195, v151, v151
    v_fma_f32 v192, v192, s35, v207
    v_fma_f32 v193, v193, s35, v207
    v_fma_f32 v194, v194, s35, v207
    v_fma_f32 v195, v195, s35, v207
    v_mul_f32 v192, v192, v148
    v_mul_f32 v193, v193, v149
    v_mul_f32 v194, v194, v150
    v_mul_f32 v195, v195, v151
    v_exp_f32 v192, v192
    v_exp_f32 v193, v193
    v_exp_f32 v194, v194
    v_exp_f32 v195, v195
    v_add_f32 v192, 1.0, v192
    v_add_f32 v193, 1.0, v193
    v_add_f32 v194, 1.0, v194
    v_add_f32 v195, 1.0, v195
    v_rcp_f32 v192, v192
    v_rcp_f32 v193, v193
    v_rcp_f32 v194, v194
    v_rcp_f32 v195, v195
    v_mul_f32 v148, v148, v192
    v_mul_f32 v149, v149, v193
    v_mul_f32 v150, v150, v194
    v_mul_f32 v151, v151, v195
    v_cvt_pk_bf16_f32 v198, v148, v149
    v_cvt_pk_bf16_f32 v199, v150, v151
    s_nop 1
    v_permlane32_swap_b32 v196, v198
    v_permlane32_swap_b32 v197, v199
    s_add_u32 s37, s36, 16896
    buffer_store_dwordx4 v[196:199], v10, s[16:19], s37 offen
    v_lshlrev_b32 v204, 16, v228
    v_and_b32 v205, 0xffff0000, v228
    v_lshlrev_b32 v206, 16, v229
    v_and_b32 v195, 0xffff0000, v229
    v_add_f32 v152, v152, v204
    v_add_f32 v153, v153, v205
    v_add_f32 v154, v154, v206
    v_add_f32 v155, v155, v195
    v_mul_f32 v192, v152, v152
    v_mul_f32 v193, v153, v153
    v_mul_f32 v194, v154, v154
    v_mul_f32 v195, v155, v155
    v_fma_f32 v192, v192, s35, v207
    v_fma_f32 v193, v193, s35, v207
    v_fma_f32 v194, v194, s35, v207
    v_fma_f32 v195, v195, s35, v207
    v_mul_f32 v192, v192, v152
    v_mul_f32 v193, v193, v153
    v_mul_f32 v194, v194, v154
    v_mul_f32 v195, v195, v155
    v_exp_f32 v192, v192
    v_exp_f32 v193, v193
    v_exp_f32 v194, v194
    v_exp_f32 v195, v195
    v_add_f32 v192, 1.0, v192
    v_add_f32 v193, 1.0, v193
    v_add_f32 v194, 1.0, v194
    v_add_f32 v195, 1.0, v195
    v_rcp_f32 v192, v192
    v_rcp_f32 v193, v193
    v_rcp_f32 v194, v194
    v_rcp_f32 v195, v195
    v_mul_f32 v152, v152, v192
    v_mul_f32 v153, v153, v193
    v_mul_f32 v154, v154, v194
    v_mul_f32 v155, v155, v195
    v_cvt_pk_bf16_f32 v200, v152, v153
    v_cvt_pk_bf16_f32 v201, v154, v155
    v_lshlrev_b32 v204, 16, v230
    v_and_b32 v205, 0xffff0000, v230
    v_lshlrev_b32 v206, 16, v231
    v_and_b32 v195, 0xffff0000, v231
    v_add_f32 v156, v156, v204
    v_add_f32 v157, v157, v205
    v_add_f32 v158, v158, v206
    v_add_f32 v159, v159, v195
    v_mul_f32 v192, v156, v156
    v_mul_f32 v193, v157, v157
    v_mul_f32 v194, v158, v158
    v_mul_f32 v195, v159, v159
    v_fma_f32 v192, v192, s35, v207
    v_fma_f32 v193, v193, s35, v207
    v_fma_f32 v194, v194, s35, v207
    v_fma_f32 v195, v195, s35, v207
    v_mul_f32 v192, v192, v156
    v_mul_f32 v193, v193, v157
    v_mul_f32 v194, v194, v158
    v_mul_f32 v195, v195, v159
    v_exp_f32 v192, v192
    v_exp_f32 v193, v193
    v_exp_f32 v194, v194
    v_exp_f32 v195, v195
    v_add_f32 v192, 1.0, v192
    v_add_f32 v193, 1.0, v193
    v_add_f32 v194, 1.0, v194
    v_add_f32 v195, 1.0, v195
    v_rcp_f32 v192, v192
    v_rcp_f32 v193, v193
    v_rcp_f32 v194, v194
    v_rcp_f32 v195, v195
    v_mul_f32 v156, v156, v192
    v_mul_f32 v157, v157, v193
    v_mul_f32 v158, v158, v194
    v_mul_f32 v159, v159, v195
    v_cvt_pk_bf16_f32 v202, v156, v157
    v_cvt_pk_bf16_f32 v203, v158, v159
    s_nop 1
    v_permlane32_swap_b32 v200, v202
    v_permlane32_swap_b32 v201, v203
    s_add_u32 s37, s36, 20992
    buffer_store_dwordx4 v[200:203], v10, s[16:19], s37 offen
    v_lshlrev_b32 v204, 16, v232
    v_and_b32 v205, 0xffff0000, v232
    v_lshlrev_b32 v206, 16, v233
    v_and_b32 v195, 0xffff0000, v233
    v_add_f32 v160, v160, v204
    v_add_f32 v161, v161, v205
    v_add_f32 v162, v162, v206
    v_add_f32 v163, v163, v195
    v_mul_f32 v192, v160, v160
    v_mul_f32 v193, v161, v161
    v_mul_f32 v194, v162, v162
    v_mul_f32 v195, v163, v163
    v_fma_f32 v192, v192, s35, v207
    v_fma_f32 v193, v193, s35, v207
    v_fma_f32 v194, v194, s35, v207
    v_fma_f32 v195, v195, s35, v207
    v_mul_f32 v192, v192, v160
    v_mul_f32 v193, v193, v161
    v_mul_f32 v194, v194, v162
    v_mul_f32 v195, v195, v163
    v_exp_f32 v192, v192
    v_exp_f32 v193, v193
    v_exp_f32 v194, v194
    v_exp_f32 v195, v195
    v_add_f32 v192, 1.0, v192
    v_add_f32 v193, 1.0, v193
    v_add_f32 v194, 1.0, v194
    v_add_f32 v195, 1.0, v195
    v_rcp_f32 v192, v192
    v_rcp_f32 v193, v193
    v_rcp_f32 v194, v194
    v_rcp_f32 v195, v195
    v_mul_f32 v160, v160, v192
    v_mul_f32 v161, v161, v193
    v_mul_f32 v162, v162, v194
    v_mul_f32 v163, v163, v195
    v_cvt_pk_bf16_f32 v196, v160, v161
    v_cvt_pk_bf16_f32 v197, v162, v163
    v_lshlrev_b32 v204, 16, v234
    v_and_b32 v205, 0xffff0000, v234
    v_lshlrev_b32 v206, 16, v235
    v_and_b32 v195, 0xffff0000, v235
    v_add_f32 v164, v164, v204
    v_add_f32 v165, v165, v205
    v_add_f32 v166, v166, v206
    v_add_f32 v167, v167, v195
    v_mul_f32 v192, v164, v164
    v_mul_f32 v193, v165, v165
    v_mul_f32 v194, v166, v166
    v_mul_f32 v195, v167, v167
    v_fma_f32 v192, v192, s35, v207
    v_fma_f32 v193, v193, s35, v207
    v_fma_f32 v194, v194, s35, v207
    v_fma_f32 v195, v195, s35, v207
    v_mul_f32 v192, v192, v164
    v_mul_f32 v193, v193, v165
    v_mul_f32 v194, v194, v166
    v_mul_f32 v195, v195, v167
    v_exp_f32 v192, v192
    v_exp_f32 v193, v193
    v_exp_f32 v194, v194
    v_exp_f32 v195, v195
    v_add_f32 v192, 1.0, v192
    v_add_f32 v193, 1.0, v193
    v_add_f32 v194, 1.0, v194
    v_add_f32 v195, 1.0, v195
    v_rcp_f32 v192, v192
    v_rcp_f32 v193, v193
    v_rcp_f32 v194, v194
    v_rcp_f32 v195, v195
    v_mul_f32 v164, v164, v192
    v_mul_f32 v165, v165, v193
    v_mul_f32 v166, v166, v194
    v_mul_f32 v167, v167, v195
    v_cvt_pk_bf16_f32 v198, v164, v165
    v_cvt_pk_bf16_f32 v199, v166, v167
    s_nop 1
    v_permlane32_swap_b32 v196, v198
    v_permlane32_swap_b32 v197, v199
    s_add_u32 s37, s36, 24576
    buffer_store_dwordx4 v[196:199], v10, s[16:19], s37 offen
    v_lshlrev_b32 v204, 16, v236
    v_and_b32 v205, 0xffff0000, v236
    v_lshlrev_b32 v206, 16, v237
    v_and_b32 v195, 0xffff0000, v237
    v_add_f32 v168, v168, v204
    v_add_f32 v169, v169, v205
    v_add_f32 v170, v170, v206
    v_add_f32 v171, v171, v195
    v_mul_f32 v192, v168, v168
    v_mul_f32 v193, v169, v169
    v_mul_f32 v194, v170, v170
    v_mul_f32 v195, v171, v171
    v_fma_f32 v192, v192, s35, v207
    v_fma_f32 v193, v193, s35, v207
    v_fma_f32 v194, v194, s35, v207
    v_fma_f32 v195, v195, s35, v207
    v_mul_f32 v192, v192, v168
    v_mul_f32 v193, v193, v169
    v_mul_f32 v194, v194, v170
    v_mul_f32 v195, v195, v171
    v_exp_f32 v192, v192
    v_exp_f32 v193, v193
    v_exp_f32 v194, v194
    v_exp_f32 v195, v195
    v_add_f32 v192, 1.0, v192
    v_add_f32 v193, 1.0, v193
    v_add_f32 v194, 1.0, v194
    v_add_f32 v195, 1.0, v195
    v_rcp_f32 v192, v192
    v_rcp_f32 v193, v193
    v_rcp_f32 v194, v194
    v_rcp_f32 v195, v195
    v_mul_f32 v168, v168, v192
    v_mul_f32 v169, v169, v193
    v_mul_f32 v170, v170, v194
    v_mul_f32 v171, v171, v195
    v_cvt_pk_bf16_f32 v200, v168, v169
    v_cvt_pk_bf16_f32 v201, v170, v171
    v_lshlrev_b32 v204, 16, v238
    v_and_b32 v205, 0xffff0000, v238
    v_lshlrev_b32 v206, 16, v239
    v_and_b32 v195, 0xffff0000, v239
    v_add_f32 v172, v172, v204
    v_add_f32 v173, v173, v205
    v_add_f32 v174, v174, v206
    v_add_f32 v175, v175, v195
    v_mul_f32 v192, v172, v172
    v_mul_f32 v193, v173, v173
    v_mul_f32 v194, v174, v174
    v_mul_f32 v195, v175, v175
    v_fma_f32 v192, v192, s35, v207
    v_fma_f32 v193, v193, s35, v207
    v_fma_f32 v194, v194, s35, v207
    v_fma_f32 v195, v195, s35, v207
    v_mul_f32 v192, v192, v172
    v_mul_f32 v193, v193, v173
    v_mul_f32 v194, v194, v174
    v_mul_f32 v195, v195, v175
    v_exp_f32 v192, v192
    v_exp_f32 v193, v193
    v_exp_f32 v194, v194
    v_exp_f32 v195, v195
    v_add_f32 v192, 1.0, v192
    v_add_f32 v193, 1.0, v193
    v_add_f32 v194, 1.0, v194
    v_add_f32 v195, 1.0, v195
    v_rcp_f32 v192, v192
    v_rcp_f32 v193, v193
    v_rcp_f32 v194, v194
    v_rcp_f32 v195, v195
    v_mul_f32 v172, v172, v192
    v_mul_f32 v173, v173, v193
    v_mul_f32 v174, v174, v194
    v_mul_f32 v175, v175, v195
    v_cvt_pk_bf16_f32 v202, v172, v173
    v_cvt_pk_bf16_f32 v203, v174, v175
    s_nop 1
    v_permlane32_swap_b32 v200, v202
    v_permlane32_swap_b32 v201, v203
    s_add_u32 s37, s36, 28672
    buffer_store_dwordx4 v[200:203], v10, s[16:19], s37 offen
    v_lshlrev_b32 v204, 16, v232
    v_and_b32 v205, 0xffff0000, v232
    v_lshlrev_b32 v206, 16, v233
    v_and_b32 v195, 0xffff0000, v233
    v_add_f32 v176, v176, v204
    v_add_f32 v177, v177, v205
    v_add_f32 v178, v178, v206
    v_add_f32 v179, v179, v195
    v_mul_f32 v192, v176, v176
    v_mul_f32 v193, v177, v177
    v_mul_f32 v194, v178, v178
    v_mul_f32 v195, v179, v179
    v_fma_f32 v192, v192, s35, v207
    v_fma_f32 v193, v193, s35, v207
    v_fma_f32 v194, v194, s35, v207
    v_fma_f32 v195, v195, s35, v207
    v_mul_f32 v192, v192, v176
    v_mul_f32 v193, v193, v177
    v_mul_f32 v194, v194, v178
    v_mul_f32 v195, v195, v179
    v_exp_f32 v192, v192
    v_exp_f32 v193, v193
    v_exp_f32 v194, v194
    v_exp_f32 v195, v195
    v_add_f32 v192, 1.0, v192
    v_add_f32 v193, 1.0, v193
    v_add_f32 v194, 1.0, v194
    v_add_f32 v195, 1.0, v195
    v_rcp_f32 v192, v192
    v_rcp_f32 v193, v193
    v_rcp_f32 v194, v194
    v_rcp_f32 v195, v195
    v_mul_f32 v176, v176, v192
    v_mul_f32 v177, v177, v193
    v_mul_f32 v178, v178, v194
    v_mul_f32 v179, v179, v195
    v_cvt_pk_bf16_f32 v196, v176, v177
    v_cvt_pk_bf16_f32 v197, v178, v179
    v_lshlrev_b32 v204, 16, v234
    v_and_b32 v205, 0xffff0000, v234
    v_lshlrev_b32 v206, 16, v235
    v_and_b32 v195, 0xffff0000, v235
    v_add_f32 v180, v180, v204
    v_add_f32 v181, v181, v205
    v_add_f32 v182, v182, v206
    v_add_f32 v183, v183, v195
    v_mul_f32 v192, v180, v180
    v_mul_f32 v193, v181, v181
    v_mul_f32 v194, v182, v182
    v_mul_f32 v195, v183, v183
    v_fma_f32 v192, v192, s35, v207
    v_fma_f32 v193, v193, s35, v207
    v_fma_f32 v194, v194, s35, v207
    v_fma_f32 v195, v195, s35, v207
    v_mul_f32 v192, v192, v180
    v_mul_f32 v193, v193, v181
    v_mul_f32 v194, v194, v182
    v_mul_f32 v195, v195, v183
    v_exp_f32 v192, v192
    v_exp_f32 v193, v193
    v_exp_f32 v194, v194
    v_exp_f32 v195, v195
    v_add_f32 v192, 1.0, v192
    v_add_f32 v193, 1.0, v193
    v_add_f32 v194, 1.0, v194
    v_add_f32 v195, 1.0, v195
    v_rcp_f32 v192, v192
    v_rcp_f32 v193, v193
    v_rcp_f32 v194, v194
    v_rcp_f32 v195, v195
    v_mul_f32 v180, v180, v192
    v_mul_f32 v181, v181, v193
    v_mul_f32 v182, v182, v194
    v_mul_f32 v183, v183, v195
    v_cvt_pk_bf16_f32 v198, v180, v181
    v_cvt_pk_bf16_f32 v199, v182, v183
    s_nop 1
    v_permlane32_swap_b32 v196, v198
    v_permlane32_swap_b32 v197, v199
    s_add_u32 s37, s36, 25088
    buffer_store_dwordx4 v[196:199], v10, s[16:19], s37 offen
    v_lshlrev_b32 v204, 16, v236
    v_and_b32 v205, 0xffff0000, v236
    v_lshlrev_b32 v206, 16, v237
    v_and_b32 v195, 0xffff0000, v237
    v_add_f32 v184, v184, v204
    v_add_f32 v185, v185, v205
    v_add_f32 v186, v186, v206
    v_add_f32 v187, v187, v195
    v_mul_f32 v192, v184, v184
    v_mul_f32 v193, v185, v185
    v_mul_f32 v194, v186, v186
    v_mul_f32 v195, v187, v187
    v_fma_f32 v192, v192, s35, v207
    v_fma_f32 v193, v193, s35, v207
    v_fma_f32 v194, v194, s35, v207
    v_fma_f32 v195, v195, s35, v207
    v_mul_f32 v192, v192, v184
    v_mul_f32 v193, v193, v185
    v_mul_f32 v194, v194, v186
    v_mul_f32 v195, v195, v187
    v_exp_f32 v192, v192
    v_exp_f32 v193, v193
    v_exp_f32 v194, v194
    v_exp_f32 v195, v195
    v_add_f32 v192, 1.0, v192
    v_add_f32 v193, 1.0, v193
    v_add_f32 v194, 1.0, v194
    v_add_f32 v195, 1.0, v195
    v_rcp_f32 v192, v192
    v_rcp_f32 v193, v193
    v_rcp_f32 v194, v194
    v_rcp_f32 v195, v195
    v_mul_f32 v184, v184, v192
    v_mul_f32 v185, v185, v193
    v_mul_f32 v186, v186, v194
    v_mul_f32 v187, v187, v195
    v_cvt_pk_bf16_f32 v200, v184, v185
    v_cvt_pk_bf16_f32 v201, v186, v187
    v_lshlrev_b32 v204, 16, v238
    v_and_b32 v205, 0xffff0000, v238
    v_lshlrev_b32 v206, 16, v239
    v_and_b32 v195, 0xffff0000, v239
    v_add_f32 v188, v188, v204
    v_add_f32 v189, v189, v205
    v_add_f32 v190, v190, v206
    v_add_f32 v191, v191, v195
    v_mul_f32 v192, v188, v188
    v_mul_f32 v193, v189, v189
    v_mul_f32 v194, v190, v190
    v_mul_f32 v195, v191, v191
    v_fma_f32 v192, v192, s35, v207
    v_fma_f32 v193, v193, s35, v207
    v_fma_f32 v194, v194, s35, v207
    v_fma_f32 v195, v195, s35, v207
    v_mul_f32 v192, v192, v188
    v_mul_f32 v193, v193, v189
    v_mul_f32 v194, v194, v190
    v_mul_f32 v195, v195, v191
    v_exp_f32 v192, v192
    v_exp_f32 v193, v193
    v_exp_f32 v194, v194
    v_exp_f32 v195, v195
    v_add_f32 v192, 1.0, v192
    v_add_f32 v193, 1.0, v193
    v_add_f32 v194, 1.0, v194
    v_add_f32 v195, 1.0, v195
    v_rcp_f32 v192, v192
    v_rcp_f32 v193, v193
    v_rcp_f32 v194, v194
    v_rcp_f32 v195, v195
    v_mul_f32 v188, v188, v192
    v_mul_f32 v189, v189, v193
    v_mul_f32 v190, v190, v194
    v_mul_f32 v191, v191, v195
    v_cvt_pk_bf16_f32 v202, v188, v189
    v_cvt_pk_bf16_f32 v203, v190, v191
    s_nop 1
    v_permlane32_swap_b32 v200, v202
    v_permlane32_swap_b32 v201, v203
    s_add_u32 s37, s36, 29184
    buffer_store_dwordx4 v[200:203], v10, s[16:19], s37 offen
GA_EXIT:
    s_endpgm
.globl attn_kernel
.p2align 8
.type attn_kernel,@function
attn_kernel:
    s_cmp_ge_u32 s2, 256
    s_cbranch_scc1 AT_EXIT
    s_load_dwordx2 s[42:43], s[0:1], 104
    s_load_dwordx2 s[52:53], s[0:1], 40
    s_load_dwordx2 s[54:55], s[0:1], 72
    v_lshrrev_b32 v1, 6, v0
    s_nop 0
    v_readfirstlane_b32 s3, v1
    v_and_b32 v1, 63, v0
    s_nop 3
    s_lshr_b32 s4, s3, 2
    s_and_b32 s5, s3, 3
    s_and_b32 s31, s2, 7
    s_lshr_b32 s32, s2, 3
    s_and_b32 s6, s32, 3
    s_lshl_b32 s6, s6, 3
    s_add_u32 s6, s6, s31
    s_lshr_b32 s7, s32, 2
    s_mov_b32 s30, 0x3e0293ee
    s_mov_b32 s38, 0x41000000
    s_waitcnt lgkmcnt(0)
    s_mov_b32 s44, s52
    s_mov_b32 s45, s53
    s_mov_b32 s46, 4194304
    s_mov_b32 s47, 0x00020000
    s_mov_b32 s48, s54
    s_mov_b32 s49, s55
    s_mov_b32 s50, 1409024
    s_mov_b32 s51, 0x00020000
    s_lshl_b32 s31, s2, 3
    s_add_u32 s31, s31, s3
    v_lshlrev_b32 v2, 4, v1
    s_lshl_b32 s32, s31, 11
    buffer_load_dwordx4 v[192:195], v2, s[44:47], s32 offen
    buffer_load_dwordx4 v[196:199], v2, s[44:47], s32 offen offset:1024
    s_lshl_b32 s32, s31, 10
    buffer_load_dwordx4 v[200:203], v2, s[48:51], s32 offen
    s_add_u32 s44, s42, 4194304
    s_addc_u32 s45, s43, 0
    s_mov_b32 s8, s44
    s_mov_b32 s9, s45
    s_mov_b32 s10, 16777216
    s_mov_b32 s11, 0x00020000
    s_add_u32 s44, s42, 20971520
    s_addc_u32 s45, s43, 0
    s_mov_b32 s12, s44
    s_mov_b32 s13, s45
    s_mov_b32 s14, 16777216
    s_mov_b32 s15, 0x00020000
    s_add_u32 s44, s42, 37748736
    s_addc_u32 s45, s43, 0
    s_mov_b32 s16, s44
    s_mov_b32 s17, s45
    s_mov_b32 s18, 16777216
    s_mov_b32 s19, 0x00020000
    s_add_u32 s44, s42, 54525952
    s_addc_u32 s45, s43, 0
    s_mov_b32 s20, s44
    s_mov_b32 s21, s45
    s_mov_b32 s22, 23068672
    s_mov_b32 s23, 0x00020000
    v_lshrrev_b32 v224, 5, v1
    v_and_b32 v225, 31, v1
    v_and_b32 v226, 15, v1
    s_mul_i32 s28, s4, 67584
    v_lshlrev_b32 v2, 4, v225
    v_lshl_add_u32 v2, v224, 10, v2
    v_add_u32 v2, s28, v2
    v_lshrrev_b32 v227, 2, v226
    v_and_b32 v228, 3, v226
    v_bfe_u32 v229, v1, 4, 1
    v_lshrrev_b32 v230, 1, v228
    v_lshl_add_u32 v229, v229, 1, v230
    v_mul_u32_u24 v229, 1088, v229
    v_lshl_add_u32 v230, v224, 2, v227
    v_lshl_add_u32 v229, v230, 4, v229
    v_and_b32 v230, 1, v228
    v_lshl_add_u32 v229, v230, 3, v229
    s_add_u32 s32, s28, 16384
    v_add_u32 v3, s32, v229
    v_lshlrev_b32 v4, 4, v1
    s_lshl_b32 s32, s5, 5
    s_lshl_b32 s33, s4, 6
    s_sub_u32 s32, s32, s33
    v_add_u32 v7, s32, v225
    v_lshlrev_b32 v227, 2, v224
    v_sub_u32 v7, v7, v227
    v_mov_b32 v8, 0xff800000
    s_lshl_b32 s32, s5, 5
    v_add_u32 v9, s32, v225
    v_lshlrev_b32 v9, 4, v9
    v_lshl_add_u32 v9, v224, 11, v9
    s_lshl_b32 s29, s6, 15
    s_lshl_b32 s31, s4, 10
    s_add_u32 s29, s29, s31
    s_mov_b32 s26, 0
    s_mov_b32 s27, 0
    s_mov_b32 s34, s29
    s_lshl_b32 s32, s5, 10
    s_add_u32 s32, s32, s28
    s_add_u32 m0, s32, 0
    s_lshl_b32 s31, s5, 11
    s_add_u32 s31, s31, s34
    s_add_u32 s31, s31, 0
    buffer_load_dwordx4 v4, s[12:15], s31 offen lds
    s_lshl_b32 s32, s5, 10
    s_add_u32 s32, s32, s28
    s_add_u32 m0, s32, 4096
    s_lshl_b32 s31, s5, 11
    s_add_u32 s31, s31, s34
    s_add_u32 s31, s31, 8192
    buffer_load_dwordx4 v4, s[12:15], s31 offen lds
    s_lshl_b32 s32, s5, 10
    s_add_u32 s32, s32, s28
    s_add_u32 m0, s32, 8192
    s_lshl_b32 s31, s5, 11
    s_add_u32 s31, s31, s34
    s_add_u32 s31, s31, 16384
    buffer_load_dwordx4 v4, s[12:15], s31 offen lds
    s_lshl_b32 s32, s5, 10
    s_add_u32 s32, s32, s28
    s_add_u32 m0, s32, 12288
    s_lshl_b32 s31, s5, 11
    s_add_u32 s31, s31, s34
    s_add_u32 s31, s31, 24576
    buffer_load_dwordx4 v4, s[12:15], s31 offen lds
    s_mul_i32 s32, s5, 1088
    s_add_u32 s32, s32, s28
    s_add_u32 m0, s32, 16384
    s_lshl_b32 s31, s5, 11
    s_add_u32 s31, s31, s34
    s_add_u32 s31, s31, 0
    buffer_load_dwordx4 v4, s[16:19], s31 offen lds
    s_mul_i32 s32, s5, 1088
    s_add_u32 s32, s32, s28
    s_add_u32 m0, s32, 20736
    s_lshl_b32 s31, s5, 11
    s_add_u32 s31, s31, s34
    s_add_u32 s31, s31, 8192
    buffer_load_dwordx4 v4, s[16:19], s31 offen lds
    s_mul_i32 s32, s5, 1088
    s_add_u32 s32, s32, s28
    s_add_u32 m0, s32, 25088
    s_lshl_b32 s31, s5, 11
    s_add_u32 s31, s31, s34
    s_add_u32 s31, s31, 16384
    buffer_load_dwordx4 v4, s[16:19], s31 offen lds
    s_mul_i32 s32, s5, 1088
    s_add_u32 s32, s32, s28
    s_add_u32 m0, s32, 29440
    s_lshl_b32 s31, s5, 11
    s_add_u32 s31, s31, s34
    s_add_u32 s31, s31, 24576
    buffer_load_dwordx4 v4, s[16:19], s31 offen lds
AT_QBLOCK:
    s_sub_u32 s31, 15, s7
    s_cmp_eq_u32 s26, 0
    s_cselect_b32 s24, s31, s7
    s_lshl_b32 s31, s24, 20
    s_lshl_b32 s32, s6, 15
    s_add_u32 s31, s31, s32
    s_add_u32 s32, s31, 0
    buffer_load_dwordx4 v[32:35], v9, s[8:11], s32 offen
    s_add_u32 s32, s31, 4096
    buffer_load_dwordx4 v[36:39], v9, s[8:11], s32 offen
    s_add_u32 s32, s31, 8192
    buffer_load_dwordx4 v[40:43], v9, s[8:11], s32 offen
    s_add_u32 s32, s31, 12288
    buffer_load_dwordx4 v[44:47], v9, s[8:11], s32 offen
    s_add_u32 s32, s31, 16384
    buffer_load_dwordx4 v[48:51], v9, s[8:11], s32 offen
    s_add_u32 s32, s31, 20480
    buffer_load_dwordx4 v[52:55], v9, s[8:11], s32 offen
    s_add_u32 s32, s31, 24576
    buffer_load_dwordx4 v[56:59], v9, s[8:11], s32 offen
    s_add_u32 s32, s31, 28672
    buffer_load_dwordx4 v[60:63], v9, s[8:11], s32 offen
    v_mov_b32 v128, 0
    v_mov_b32 v129, 0
    v_mov_b32 v130, 0
    v_mov_b32 v131, 0
    v_mov_b32 v132, 0
    v_mov_b32 v133, 0
    v_mov_b32 v134, 0
    v_mov_b32 v135, 0
    v_mov_b32 v136, 0
    v_mov_b32 v137, 0
    v_mov_b32 v138, 0
    v_mov_b32 v139, 0
    v_mov_b32 v140, 0
    v_mov_b32 v141, 0
    v_mov_b32 v142, 0
    v_mov_b32 v143, 0
    v_mov_b32 v144, 0
    v_mov_b32 v145, 0
    v_mov_b32 v146, 0
    v_mov_b32 v147, 0
    v_mov_b32 v148, 0
    v_mov_b32 v149, 0
    v_mov_b32 v150, 0
    v_mov_b32 v151, 0
    v_mov_b32 v152, 0
    v_mov_b32 v153, 0
    v_mov_b32 v154, 0
    v_mov_b32 v155, 0
    v_mov_b32 v156, 0
    v_mov_b32 v157, 0
    v_mov_b32 v158, 0
    v_mov_b32 v159, 0
    v_mov_b32 v160, 0
    v_mov_b32 v161, 0
    v_mov_b32 v162, 0
    v_mov_b32 v163, 0
    v_mov_b32 v164, 0
    v_mov_b32 v165, 0
    v_mov_b32 v166, 0
    v_mov_b32 v167, 0
    v_mov_b32 v168, 0
    v_mov_b32 v169, 0
    v_mov_b32 v170, 0
    v_mov_b32 v171, 0
    v_mov_b32 v172, 0
    v_mov_b32 v173, 0
    v_mov_b32 v174, 0
    v_mov_b32 v175, 0
    v_mov_b32 v176, 0
    v_mov_b32 v177, 0
    v_mov_b32 v178, 0
    v_mov_b32 v179, 0
    v_mov_b32 v180, 0
    v_mov_b32 v181, 0
    v_mov_b32 v182, 0
    v_mov_b32 v183, 0
    v_mov_b32 v184, 0
    v_mov_b32 v185, 0
    v_mov_b32 v186, 0
    v_mov_b32 v187, 0
    v_mov_b32 v188, 0
    v_mov_b32 v189, 0
    v_mov_b32 v190, 0
    v_mov_b32 v191, 0
    v_mov_b32 v5, 0xf149f2ca
    v_mov_b32 v6, 0
    s_mov_b32 s25, 0
    s_cmp_eq_u32 s27, 0
    s_cbranch_scc0 AT_PRIME1
    s_waitcnt vmcnt(0)
    s_barrier
    s_cmp_eq_u32 s24, 0
    s_cbranch_scc1 AT_PK_1
    s_add_u32 s34, s29, 1048576
    s_lshl_b32 s32, s5, 10
    s_add_u32 s32, s32, s28
    s_add_u32 m0, s32, 33792
    s_lshl_b32 s31, s5, 11
    s_add_u32 s31, s31, s34
    s_add_u32 s31, s31, 0
    buffer_load_dwordx4 v4, s[12:15], s31 offen lds
    s_lshl_b32 s32, s5, 10
    s_add_u32 s32, s32, s28
    s_add_u32 m0, s32, 37888
    s_lshl_b32 s31, s5, 11
    s_add_u32 s31, s31, s34
    s_add_u32 s31, s31, 8192
    buffer_load_dwordx4 v4, s[12:15], s31 offen lds
    s_lshl_b32 s32, s5, 10
    s_add_u32 s32, s32, s28
    s_add_u32 m0, s32, 41984
    s_lshl_b32 s31, s5, 11
    s_add_u32 s31, s31, s34
    s_add_u32 s31, s31, 16384
    buffer_load_dwordx4 v4, s[12:15], s31 offen lds
    s_lshl_b32 s32, s5, 10
    s_add_u32 s32, s32, s28
    s_add_u32 m0, s32, 46080
    s_lshl_b32 s31, s5, 11
    s_add_u32 s31, s31, s34
    s_add_u32 s31, s31, 24576
    buffer_load_dwordx4 v4, s[12:15], s31 offen lds
AT_PK_1:
    ds_read_b128 v[192:195], v2 offset:0
    ds_read_b128 v[196:199], v2 offset:2048
    ds_read_b128 v[200:203], v2 offset:4096
    s_waitcnt lgkmcnt(2)
    v_mfma_f32_32x32x16_bf16 v[64:79], v[192:195], v[32:35], 0
    ds_read_b128 v[204:207], v2 offset:6144
    s_waitcnt lgkmcnt(2)
    v_mfma_f32_32x32x16_bf16 v[64:79], v[196:199], v[36:39], v[64:79]
    ds_read_b128 v[192:195], v2 offset:8192
    s_waitcnt lgkmcnt(2)
    v_mfma_f32_32x32x16_bf16 v[64:79], v[200:203], v[40:43], v[64:79]
    ds_read_b128 v[196:199], v2 offset:10240
    s_waitcnt lgkmcnt(2)
    v_mfma_f32_32x32x16_bf16 v[64:79], v[204:207], v[44:47], v[64:79]
    ds_read_b128 v[200:203], v2 offset:12288
    s_waitcnt lgkmcnt(2)
    v_mfma_f32_32x32x16_bf16 v[64:79], v[192:195], v[48:51], v[64:79]
    ds_read_b128 v[204:207], v2 offset:14336
    s_waitcnt lgkmcnt(2)
    v_mfma_f32_32x32x16_bf16 v[64:79], v[196:199], v[52:55], v[64:79]
    ds_read_b128 v[192:195], v2 offset:512
    s_waitcnt lgkmcnt(2)
    v_mfma_f32_32x32x16_bf16 v[64:79], v[200:203], v[56:59], v[64:79]
    ds_read_b128 v[196:199], v2 offset:2560
    s_waitcnt lgkmcnt(2)
    v_mfma_f32_32x32x16_bf16 v[64:79], v[204:207], v[60:63], v[64:79]
    ds_read_b128 v[200:203], v2 offset:4608
    s_waitcnt lgkmcnt(2)
    v_mfma_f32_32x32x16_bf16 v[80:95], v[192:195], v[32:35], 0
    ds_read_b128 v[204:207], v2 offset:6656
    s_waitcnt lgkmcnt(2)
    v_mfma_f32_32x32x16_bf16 v[80:95], v[196:199], v[36:39], v[80:95]
    ds_read_b128 v[192:195], v2 offset:8704
    s_waitcnt lgkmcnt(2)
    v_mfma_f32_32x32x16_bf16 v[80:95], v[200:203], v[40:43], v[80:95]
    ds_read_b128 v[196:199], v2 offset:10752
    s_waitcnt lgkmcnt(2)
    v_mfma_f32_32x32x16_bf16 v[80:95], v[204:207], v[44:47], v[80:95]
    ds_read_b128 v[200:203], v2 offset:12800
    s_waitcnt lgkmcnt(2)
    v_mfma_f32_32x32x16_bf16 v[80:95], v[192:195], v[48:51], v[80:95]
    ds_read_b128 v[204:207], v2 offset:14848
    s_waitcnt lgkmcnt(2)
    v_mfma_f32_32x32x16_bf16 v[80:95], v[196:199], v[52:55], v[80:95]
    s_waitcnt lgkmcnt(1)
    v_mfma_f32_32x32x16_bf16 v[80:95], v[200:203], v[56:59], v[80:95]
    s_waitcnt lgkmcnt(0)
    v_mfma_f32_32x32x16_bf16 v[80:95], v[204:207], v[60:63], v[80:95]
    s_cmp_eq_u32 s24, 0
    s_cbranch_scc0 AT_PM_2
    v_cmp_gt_i32 vcc, 0, v7
    s_nop 1
    v_cndmask_b32 v64, v64, v8, vcc
    v_cmp_gt_i32 vcc, 1, v7
    s_nop 1
    v_cndmask_b32 v65, v65, v8, vcc
    v_cmp_gt_i32 vcc, 2, v7
    s_nop 1
    v_cndmask_b32 v66, v66, v8, vcc
    v_cmp_gt_i32 vcc, 3, v7
    s_nop 1
    v_cndmask_b32 v67, v67, v8, vcc
    v_cmp_gt_i32 vcc, 8, v7
    s_nop 1
    v_cndmask_b32 v68, v68, v8, vcc
    v_cmp_gt_i32 vcc, 9, v7
    s_nop 1
    v_cndmask_b32 v69, v69, v8, vcc
    v_cmp_gt_i32 vcc, 10, v7
    s_nop 1
    v_cndmask_b32 v70, v70, v8, vcc
    v_cmp_gt_i32 vcc, 11, v7
    s_nop 1
    v_cndmask_b32 v71, v71, v8, vcc
    v_cmp_gt_i32 vcc, 16, v7
    s_nop 1
    v_cndmask_b32 v72, v72, v8, vcc
    v_cmp_gt_i32 vcc, 17, v7
    s_nop 1
    v_cndmask_b32 v73, v73, v8, vcc
    v_cmp_gt_i32 vcc, 18, v7
    s_nop 1
    v_cndmask_b32 v74, v74, v8, vcc
    v_cmp_gt_i32 vcc, 19, v7
    s_nop 1
    v_cndmask_b32 v75, v75, v8, vcc
    v_cmp_gt_i32 vcc, 24, v7
    s_nop 1
    v_cndmask_b32 v76, v76, v8, vcc
    v_cmp_gt_i32 vcc, 25, v7
    s_nop 1
    v_cndmask_b32 v77, v77, v8, vcc
    v_cmp_gt_i32 vcc, 26, v7
    s_nop 1
    v_cndmask_b32 v78, v78, v8, vcc
    v_cmp_gt_i32 vcc, 27, v7
    s_nop 1
    v_cndmask_b32 v79, v79, v8, vcc
    v_cmp_gt_i32 vcc, 32, v7
    s_nop 1
    v_cndmask_b32 v80, v80, v8, vcc
    v_cmp_gt_i32 vcc, 33, v7
    s_nop 1
    v_cndmask_b32 v81, v81, v8, vcc
    v_cmp_gt_i32 vcc, 34, v7
    s_nop 1
    v_cndmask_b32 v82, v82, v8, vcc
    v_cmp_gt_i32 vcc, 35, v7
    s_nop 1
    v_cndmask_b32 v83, v83, v8, vcc
    v_cmp_gt_i32 vcc, 40, v7
    s_nop 1
    v_cndmask_b32 v84, v84, v8, vcc
    v_cmp_gt_i32 vcc, 41, v7
    s_nop 1
    v_cndmask_b32 v85, v85, v8, vcc
    v_cmp_gt_i32 vcc, 42, v7
    s_nop 1
    v_cndmask_b32 v86, v86, v8, vcc
    v_cmp_gt_i32 vcc, 43, v7
    s_nop 1
    v_cndmask_b32 v87, v87, v8, vcc
    v_cmp_gt_i32 vcc, 48, v7
    s_nop 1
    v_cndmask_b32 v88, v88, v8, vcc
    v_cmp_gt_i32 vcc, 49, v7
    s_nop 1
    v_cndmask_b32 v89, v89, v8, vcc
    v_cmp_gt_i32 vcc, 50, v7
    s_nop 1
    v_cndmask_b32 v90, v90, v8, vcc
    v_cmp_gt_i32 vcc, 51, v7
    s_nop 1
    v_cndmask_b32 v91, v91, v8, vcc
    v_cmp_gt_i32 vcc, 56, v7
    s_nop 1
    v_cndmask_b32 v92, v92, v8, vcc
    v_cmp_gt_i32 vcc, 57, v7
    s_nop 1
    v_cndmask_b32 v93, v93, v8, vcc
    v_cmp_gt_i32 vcc, 58, v7
    s_nop 1
    v_cndmask_b32 v94, v94, v8, vcc
    v_cmp_gt_i32 vcc, 59, v7
    s_nop 1
    v_cndmask_b32 v95, v95, v8, vcc
AT_PM_2:
    v_max3_f32 v224, v64, v65, v66
    v_max3_f32 v224, v224, v67, v68
    v_max3_f32 v224, v224, v69, v70
    v_max3_f32 v224, v224, v71, v72
    v_max3_f32 v224, v224, v73, v74
    v_max3_f32 v224, v224, v75, v76
    v_max3_f32 v224, v224, v77, v78
    v_max_f32 v224, v224, v79
    v_mov_b32 v226, v224
    s_nop 1
    v_permlane32_swap_b32 v224, v226
    v_max_f32 v224, v224, v226
    v_sub_f32 v226, v224, v5
    v_mul_f32 v226, s30, v226
    v_cmp_lt_f32 vcc, s38, v226
    v_mov_b32 v227, 1.0
    s_mov_b64 s[36:37], vcc
    s_nop 3
    s_cbranch_vccz AT_NR_3
    v_max_f32 v226, v224, v5
    v_sub_f32 v227, v5, v226
    v_mul_f32 v227, s30, v227
    v_exp_f32 v227, v227
    v_mov_b32 v5, v226
AT_NR_3:
    v_mul_f32 v228, s30, v5
    v_fma_f32 v64, v64, s30, -v228
    v_fma_f32 v65, v65, s30, -v228
    v_fma_f32 v66, v66, s30, -v228
    v_fma_f32 v67, v67, s30, -v228
    v_fma_f32 v68, v68, s30, -v228
    v_fma_f32 v69, v69, s30, -v228
    v_fma_f32 v70, v70, s30, -v228
    v_fma_f32 v71, v71, s30, -v228
    v_fma_f32 v72, v72, s30, -v228
    v_fma_f32 v73, v73, s30, -v228
    v_fma_f32 v74, v74, s30, -v228
    v_fma_f32 v75, v75, s30, -v228
    v_fma_f32 v76, v76, s30, -v228
    v_fma_f32 v77, v77, s30, -v228
    v_fma_f32 v78, v78, s30, -v228
    v_fma_f32 v79, v79, s30, -v228
    v_exp_f32 v64, v64
    v_exp_f32 v65, v65
    v_exp_f32 v66, v66
    v_exp_f32 v67, v67
    v_exp_f32 v68, v68
    v_exp_f32 v69, v69
    s_branch AT_ITER
AT_PRIME1:
    s_waitcnt vmcnt(0)
    s_barrier
    s_cmp_eq_u32 s24, 0
    s_cbranch_scc1 AT_PK_4
    s_add_u32 s34, s29, 1048576
    s_lshl_b32 s32, s5, 10
    s_add_u32 s32, s32, s28
    s_add_u32 m0, s32, 0
    s_lshl_b32 s31, s5, 11
    s_add_u32 s31, s31, s34
    s_add_u32 s31, s31, 0
    buffer_load_dwordx4 v4, s[12:15], s31 offen lds
    s_lshl_b32 s32, s5, 10
    s_add_u32 s32, s32, s28
    s_add_u32 m0, s32, 4096
    s_lshl_b32 s31, s5, 11
    s_add_u32 s31, s31, s34
    s_add_u32 s31, s31, 8192
    buffer_load_dwordx4 v4, s[12:15], s31 offen lds
    s_lshl_b32 s32, s5, 10
    s_add_u32 s32, s32, s28
    s_add_u32 m0, s32, 8192
    s_lshl_b32 s31, s5, 11
    s_add_u32 s31, s31, s34
    s_add_u32 s31, s31, 16384
    buffer_load_dwordx4 v4, s[12:15], s31 offen lds
    s_lshl_b32 s32, s5, 10
    s_add_u32 s32, s32, s28
    s_add_u32 m0, s32, 12288
    s_lshl_b32 s31, s5, 11
    s_add_u32 s31, s31, s34
    s_add_u32 s31, s31, 24576
    buffer_load_dwordx4 v4, s[12:15], s31 offen lds
AT_PK_4:
    ds_read_b128 v[192:195], v2 offset:33792
    ds_read_b128 v[196:199], v2 offset:35840
    ds_read_b128 v[200:203], v2 offset:37888
    s_waitcnt lgkmcnt(2)
    v_mfma_f32_32x32x16_bf16 v[96:111], v[192:195], v[32:35], 0
    ds_read_b128 v[204:207], v2 offset:39936
    s_waitcnt lgkmcnt(2)
    v_mfma_f32_32x32x16_bf16 v[96:111], v[196:199], v[36:39], v[96:111]
    ds_read_b128 v[192:195], v2 offset:41984
    s_waitcnt lgkmcnt(2)
    v_mfma_f32_32x32x16_bf16 v[96:111], v[200:203], v[40:43], v[96:111]
    ds_read_b128 v[196:199], v2 offset:44032
    s_waitcnt lgkmcnt(2)
    v_mfma_f32_32x32x16_bf16 v[96:111], v[204:207], v[44:47], v[96:111]
    ds_read_b128 v[200:203], v2 offset:46080
    s_waitcnt lgkmcnt(2)
    v_mfma_f32_32x32x16_bf16 v[96:111], v[192:195], v[48:51], v[96:111]
    ds_read_b128 v[204:207], v2 offset:48128
    s_waitcnt lgkmcnt(2)
    v_mfma_f32_32x32x16_bf16 v[96:111], v[196:199], v[52:55], v[96:111]
    ds_read_b128 v[192:195], v2 offset:34304
    s_waitcnt lgkmcnt(2)
    v_mfma_f32_32x32x16_bf16 v[96:111], v[200:203], v[56:59], v[96:111]
    ds_read_b128 v[196:199], v2 offset:36352
    s_waitcnt lgkmcnt(2)
    v_mfma_f32_32x32x16_bf16 v[96:111], v[204:207], v[60:63], v[96:111]
    ds_read_b128 v[200:203], v2 offset:38400
    s_waitcnt lgkmcnt(2)
    v_mfma_f32_32x32x16_bf16 v[112:127], v[192:195], v[32:35], 0
    ds_read_b128 v[204:207], v2 offset:40448
    s_waitcnt lgkmcnt(2)
    v_mfma_f32_32x32x16_bf16 v[112:127], v[196:199], v[36:39], v[112:127]
    ds_read_b128 v[192:195], v2 offset:42496
    s_waitcnt lgkmcnt(2)
    v_mfma_f32_32x32x16_bf16 v[112:127], v[200:203], v[40:43], v[112:127]
    ds_read_b128 v[196:199], v2 offset:44544
    s_waitcnt lgkmcnt(2)
    v_mfma_f32_32x32x16_bf16 v[112:127], v[204:207], v[44:47], v[112:127]
    ds_read_b128 v[200:203], v2 offset:46592
    s_waitcnt lgkmcnt(2)
    v_mfma_f32_32x32x16_bf16 v[112:127], v[192:195], v[48:51], v[112:127]
    ds_read_b128 v[204:207], v2 offset:48640
    s_waitcnt lgkmcnt(2)
    v_mfma_f32_32x32x16_bf16 v[112:127], v[196:199], v[52:55], v[112:127]
    s_waitcnt lgkmcnt(1)
    v_mfma_f32_32x32x16_bf16 v[112:127], v[200:203], v[56:59], v[112:127]
    s_waitcnt lgkmcnt(0)
    v_mfma_f32_32x32x16_bf16 v[112:127], v[204:207], v[60:63], v[112:127]
    s_cmp_eq_u32 s24, 0
    s_cbranch_scc0 AT_PM_5
    v_cmp_gt_i32 vcc, 0, v7
    s_nop 1
    v_cndmask_b32 v96, v96, v8, vcc
    v_cmp_gt_i32 vcc, 1, v7
    s_nop 1
    v_cndmask_b32 v97, v97, v8, vcc
    v_cmp_gt_i32 vcc, 2, v7
    s_nop 1
    v_cndmask_b32 v98, v98, v8, vcc
    v_cmp_gt_i32 vcc, 3, v7
    s_nop 1
    v_cndmask_b32 v99, v99, v8, vcc
    v_cmp_gt_i32 vcc, 8, v7
    s_nop 1
    v_cndmask_b32 v100, v100, v8, vcc
    v_cmp_gt_i32 vcc, 9, v7
    s_nop 1
    v_cndmask_b32 v101, v101, v8, vcc
    v_cmp_gt_i32 vcc, 10, v7
    s_nop 1
    v_cndmask_b32 v102, v102, v8, vcc
    v_cmp_gt_i32 vcc, 11, v7
    s_nop 1
    v_cndmask_b32 v103, v103, v8, vcc
    v_cmp_gt_i32 vcc, 16, v7
    s_nop 1
    v_cndmask_b32 v104, v104, v8, vcc
    v_cmp_gt_i32 vcc, 17, v7
    s_nop 1
    v_cndmask_b32 v105, v105, v8, vcc
    v_cmp_gt_i32 vcc, 18, v7
    s_nop 1
    v_cndmask_b32 v106, v106, v8, vcc
    v_cmp_gt_i32 vcc, 19, v7
    s_nop 1
    v_cndmask_b32 v107, v107, v8, vcc
    v_cmp_gt_i32 vcc, 24, v7
    s_nop 1
    v_cndmask_b32 v108, v108, v8, vcc
    v_cmp_gt_i32 vcc, 25, v7
    s_nop 1
    v_cndmask_b32 v109, v109, v8, vcc
    v_cmp_gt_i32 vcc, 26, v7
    s_nop 1
    v_cndmask_b32 v110, v110, v8, vcc
    v_cmp_gt_i32 vcc, 27, v7
    s_nop 1
    v_cndmask_b32 v111, v111, v8, vcc
    v_cmp_gt_i32 vcc, 32, v7
    s_nop 1
    v_cndmask_b32 v112, v112, v8, vcc
    v_cmp_gt_i32 vcc, 33, v7
    s_nop 1
    v_cndmask_b32 v113, v113, v8, vcc
    v_cmp_gt_i32 vcc, 34, v7
    s_nop 1
    v_cndmask_b32 v114, v114, v8, vcc
    v_cmp_gt_i32 vcc, 35, v7
    s_nop 1
    v_cndmask_b32 v115, v115, v8, vcc
    v_cmp_gt_i32 vcc, 40, v7
    s_nop 1
    v_cndmask_b32 v116, v116, v8, vcc
    v_cmp_gt_i32 vcc, 41, v7
    s_nop 1
    v_cndmask_b32 v117, v117, v8, vcc
    v_cmp_gt_i32 vcc, 42, v7
    s_nop 1
    v_cndmask_b32 v118, v118, v8, vcc
    v_cmp_gt_i32 vcc, 43, v7
    s_nop 1
    v_cndmask_b32 v119, v119, v8, vcc
    v_cmp_gt_i32 vcc, 48, v7
    s_nop 1
    v_cndmask_b32 v120, v120, v8, vcc
    v_cmp_gt_i32 vcc, 49, v7
    s_nop 1
    v_cndmask_b32 v121, v121, v8, vcc
    v_cmp_gt_i32 vcc, 50, v7
    s_nop 1
    v_cndmask_b32 v122, v122, v8, vcc
    v_cmp_gt_i32 vcc, 51, v7
    s_nop 1
    v_cndmask_b32 v123, v123, v8, vcc
    v_cmp_gt_i32 vcc, 56, v7
    s_nop 1
    v_cndmask_b32 v124, v124, v8, vcc
    v_cmp_gt_i32 vcc, 57, v7
    s_nop 1
    v_cndmask_b32 v125, v125, v8, vcc
    v_cmp_gt_i32 vcc, 58, v7
    s_nop 1
    v_cndmask_b32 v126, v126, v8, vcc
    v_cmp_gt_i32 vcc, 59, v7
    s_nop 1
    v_cndmask_b32 v127, v127, v8, vcc
AT_PM_5:
    v_max3_f32 v224, v96, v97, v98
    v_max3_f32 v224, v224, v99, v100
    v_max3_f32 v224, v224, v101, v102
    v_max3_f32 v224, v224, v103, v104
    v_max3_f32 v224, v224, v105, v106
    v_max3_f32 v224, v224, v107, v108
    v_max3_f32 v224, v224, v109, v110
    v_max_f32 v224, v224, v111
    v_mov_b32 v226, v224
    s_nop 1
    v_permlane32_swap_b32 v224, v226
    v_max_f32 v224, v224, v226
    v_sub_f32 v226, v224, v5
    v_mul_f32 v226, s30, v226
    v_cmp_lt_f32 vcc, s38, v226
    v_mov_b32 v227, 1.0
    s_mov_b64 s[36:37], vcc
    s_nop 3
    s_cbranch_vccz AT_NR_6
    v_max_f32 v226, v224, v5
    v_sub_f32 v227, v5, v226
    v_mul_f32 v227, s30, v227
    v_exp_f32 v227, v227
    v_mov_b32 v5, v226
AT_NR_6:
    v_mul_f32 v228, s30, v5
    v_fma_f32 v96, v96, s30, -v228
    v_fma_f32 v97, v97, s30, -v228
    v_fma_f32 v98, v98, s30, -v228
    v_fma_f32 v99, v99, s30, -v228
    v_fma_f32 v100, v100, s30, -v228
    v_fma_f32 v101, v101, s30, -v228
    v_fma_f32 v102, v102, s30, -v228
    v_fma_f32 v103, v103, s30, -v228
    v_fma_f32 v104, v104, s30, -v228
    v_fma_f32 v105, v105, s30, -v228
    v_fma_f32 v106, v106, s30, -v228
    v_fma_f32 v107, v107, s30, -v228
    v_fma_f32 v108, v108, s30, -v228
    v_fma_f32 v109, v109, s30, -v228
    v_fma_f32 v110, v110, s30, -v228
    v_fma_f32 v111, v111, s30, -v228
    v_exp_f32 v96, v96
    v_exp_f32 v97, v97
    v_exp_f32 v98, v98
    v_exp_f32 v99, v99
    v_exp_f32 v100, v100
    v_exp_f32 v101, v101
AT_ITER:
    s_cmp_lt_u32 s25, s24
    s_cbranch_scc0 AT_TAIL
    s_cmp_eq_u32 s27, 0
    s_cbranch_scc0 AT_ST1
    s_add_u32 s31, s25, 1
    s_mov_b32 s40, 1
    s_cmp_le_u32 s31, s24
    s_cbranch_scc1 AT_VT_7
    s_mov_b32 s31, 0
    s_cmp_eq_u32 s26, 0
    s_cselect_b32 s40, 1, 0
AT_VT_7:
    s_lshl_b32 s31, s31, 20
    s_add_u32 s35, s31, s29
    s_add_u32 s31, s25, 2
    s_mov_b32 s39, 1
    s_cmp_le_u32 s31, s24
    s_cbranch_scc1 AT_KT_8
    s_mov_b32 s31, 0
    s_cmp_eq_u32 s26, 0
    s_cselect_b32 s39, 1, 0
AT_KT_8:
    s_lshl_b32 s31, s31, 20
    s_add_u32 s34, s31, s29
    s_waitcnt vmcnt(0)
    s_barrier
    ds_read_b128 v[192:195], v2 offset:33792
    ds_read_b128 v[196:199], v2 offset:35840
    ds_read_b128 v[200:203], v2 offset:37888
    v_exp_f32 v70, v70
    v_exp_f32 v71, v71
    v_exp_f32 v72, v72
    v_exp_f32 v73, v73
    v_exp_f32 v74, v74
    v_exp_f32 v75, v75
    s_waitcnt lgkmcnt(2)
    v_mfma_f32_32x32x16_bf16 v[96:111], v[192:195], v[32:35], 0
    ds_read_b128 v[204:207], v2 offset:39936
    v_exp_f32 v76, v76
    v_exp_f32 v77, v77
    v_exp_f32 v78, v78
    v_exp_f32 v79, v79
    v_add_f32 v229, v64, v68
    s_waitcnt lgkmcnt(2)
    v_mfma_f32_32x32x16_bf16 v[96:111], v[196:199], v[36:39], v[96:111]
    ds_read_b128 v[192:195], v2 offset:41984
    s_cmp_eq_u32 s39, 0
    s_cbranch_scc1 AT_DK_9
    s_lshl_b32 s32, s5, 10
    s_add_u32 s32, s32, s28
    s_add_u32 m0, s32, 0
    s_lshl_b32 s31, s5, 11
    s_add_u32 s31, s31, s34
    s_add_u32 s31, s31, 0
    buffer_load_dwordx4 v4, s[12:15], s31 offen lds
AT_DK_9:
    v_add_f32 v230, v65, v69
    v_add_f32 v231, v66, v70
    v_add_f32 v232, v67, v71
    v_add_f32 v229, v229, v72
    v_add_f32 v230, v230, v73
    s_waitcnt lgkmcnt(2)
    v_mfma_f32_32x32x16_bf16 v[96:111], v[200:203], v[40:43], v[96:111]
    ds_read_b128 v[196:199], v2 offset:44032
    v_add_f32 v231, v231, v74
    v_add_f32 v232, v232, v75
    v_add_f32 v229, v229, v76
    v_add_f32 v230, v230, v77
    v_add_f32 v231, v231, v78
    s_waitcnt lgkmcnt(2)
    v_mfma_f32_32x32x16_bf16 v[96:111], v[204:207], v[44:47], v[96:111]
    ds_read_b128 v[200:203], v2 offset:46080
    s_cmp_eq_u32 s39, 0
    s_cbranch_scc1 AT_DK_10
    s_lshl_b32 s32, s5, 10
    s_add_u32 s32, s32, s28
    s_add_u32 m0, s32, 4096
    s_lshl_b32 s31, s5, 11
    s_add_u32 s31, s31, s34
    s_add_u32 s31, s31, 8192
    buffer_load_dwordx4 v4, s[12:15], s31 offen lds
AT_DK_10:
    v_add_f32 v232, v232, v79
    v_cvt_pk_bf16_f32 v16, v64, v65
    v_cvt_pk_bf16_f32 v17, v66, v67
    v_cvt_pk_bf16_f32 v18, v68, v69
    v_cvt_pk_bf16_f32 v19, v70, v71
    s_waitcnt lgkmcnt(2)
    v_mfma_f32_32x32x16_bf16 v[96:111], v[192:195], v[48:51], v[96:111]
    ds_read_b128 v[204:207], v2 offset:48128
    v_cvt_pk_bf16_f32 v20, v72, v73
    v_cvt_pk_bf16_f32 v21, v74, v75
    v_cvt_pk_bf16_f32 v22, v76, v77
    v_cvt_pk_bf16_f32 v23, v78, v79
    v_add_f32 v229, v229, v230
    s_waitcnt lgkmcnt(2)
    v_mfma_f32_32x32x16_bf16 v[96:111], v[196:199], v[52:55], v[96:111]
    ds_read_b64_tr_b16 v[208:209], v3 offset:0
    ds_read_b64_tr_b16 v[210:211], v3 offset:128
    s_cmp_eq_u32 s39, 0
    s_cbranch_scc1 AT_DK_11
    s_lshl_b32 s32, s5, 10
    s_add_u32 s32, s32, s28
    s_add_u32 m0, s32, 8192
    s_lshl_b32 s31, s5, 11
    s_add_u32 s31, s31, s34
    s_add_u32 s31, s31, 16384
    buffer_load_dwordx4 v4, s[12:15], s31 offen lds
AT_DK_11:
    v_add_f32 v231, v231, v232
    v_add_f32 v229, v229, v231
    v_fma_f32 v6, v6, v227, v229
    s_waitcnt lgkmcnt(3)
    v_mfma_f32_32x32x16_bf16 v[96:111], v[200:203], v[56:59], v[96:111]
    ds_read_b64_tr_b16 v[212:213], v3 offset:4352
    ds_read_b64_tr_b16 v[214:215], v3 offset:4480
    s_waitcnt lgkmcnt(4)
    v_mfma_f32_32x32x16_bf16 v[96:111], v[204:207], v[60:63], v[96:111]
    ds_read_b64_tr_b16 v[216:217], v3 offset:8704
    ds_read_b64_tr_b16 v[218:219], v3 offset:8832
    s_cmp_eq_u32 s39, 0
    s_cbranch_scc1 AT_DK_12
    s_lshl_b32 s32, s5, 10
    s_add_u32 s32, s32, s28
    s_add_u32 m0, s32, 12288
    s_lshl_b32 s31, s5, 11
    s_add_u32 s31, s31, s34
    s_add_u32 s31, s31, 24576
    buffer_load_dwordx4 v4, s[12:15], s31 offen lds
AT_DK_12:
    s_cmp_eq_u64 s[36:37], 0
    s_cbranch_scc1 AT_RS_13
    v_mul_f32 v128, v227, v128
    v_mul_f32 v129, v227, v129
    v_mul_f32 v130, v227, v130
    v_mul_f32 v131, v227, v131
    v_mul_f32 v132, v227, v132
    v_mul_f32 v133, v227, v133
    v_mul_f32 v134, v227, v134
    v_mul_f32 v135, v227, v135
    v_mul_f32 v136, v227, v136
    v_mul_f32 v137, v227, v137
    v_mul_f32 v138, v227, v138
    v_mul_f32 v139, v227, v139
    v_mul_f32 v140, v227, v140
    v_mul_f32 v141, v227, v141
    v_mul_f32 v142, v227, v142
    v_mul_f32 v143, v227, v143
    v_mul_f32 v144, v227, v144
    v_mul_f32 v145, v227, v145
    v_mul_f32 v146, v227, v146
    v_mul_f32 v147, v227, v147
    v_mul_f32 v148, v227, v148
    v_mul_f32 v149, v227, v149
    v_mul_f32 v150, v227, v150
    v_mul_f32 v151, v227, v151
    v_mul_f32 v152, v227, v152
    v_mul_f32 v153, v227, v153
    v_mul_f32 v154, v227, v154
    v_mul_f32 v155, v227, v155
    v_mul_f32 v156, v227, v156
    v_mul_f32 v157, v227, v157
    v_mul_f32 v158, v227, v158
    v_mul_f32 v159, v227, v159
    v_mul_f32 v160, v227, v160
    v_mul_f32 v161, v227, v161
    v_mul_f32 v162, v227, v162
    v_mul_f32 v163, v227, v163
    v_mul_f32 v164, v227, v164
    v_mul_f32 v165, v227, v165
    v_mul_f32 v166, v227, v166
    v_mul_f32 v167, v227, v167
    v_mul_f32 v168, v227, v168
    v_mul_f32 v169, v227, v169
    v_mul_f32 v170, v227, v170
    v_mul_f32 v171, v227, v171
    v_mul_f32 v172, v227, v172
    v_mul_f32 v173, v227, v173
    v_mul_f32 v174, v227, v174
    v_mul_f32 v175, v227, v175
    v_mul_f32 v176, v227, v176
    v_mul_f32 v177, v227, v177
    v_mul_f32 v178, v227, v178
    v_mul_f32 v179, v227, v179
    v_mul_f32 v180, v227, v180
    v_mul_f32 v181, v227, v181
    v_mul_f32 v182, v227, v182
    v_mul_f32 v183, v227, v183
    v_mul_f32 v184, v227, v184
    v_mul_f32 v185, v227, v185
    v_mul_f32 v186, v227, v186
    v_mul_f32 v187, v227, v187
    v_mul_f32 v188, v227, v188
    v_mul_f32 v189, v227, v189
    v_mul_f32 v190, v227, v190
    v_mul_f32 v191, v227, v191
AT_RS_13:
    s_waitcnt lgkmcnt(4)
    v_mfma_f32_32x32x16_bf16 v[128:143], v[208:211], v[16:19], v[128:143]
    ds_read_b64_tr_b16 v[220:221], v3 offset:13056
    ds_read_b64_tr_b16 v[222:223], v3 offset:13184
    v_max3_f32 v224, v80, v81, v82
    v_max3_f32 v224, v224, v83, v84
    v_max3_f32 v224, v224, v85, v86
    v_max3_f32 v224, v224, v87, v88
    v_max3_f32 v224, v224, v89, v90
    s_waitcnt lgkmcnt(4)
    v_mfma_f32_32x32x16_bf16 v[144:159], v[212:215], v[16:19], v[144:159]
    ds_read_b64_tr_b16 v[208:209], v3 offset:256
    ds_read_b64_tr_b16 v[210:211], v3 offset:384
    s_cmp_eq_u32 s40, 0
    s_cbranch_scc1 AT_DV_14
    s_mul_i32 s32, s5, 1088
    s_add_u32 s32, s32, s28
    s_add_u32 m0, s32, 50176
    s_lshl_b32 s31, s5, 11
    s_add_u32 s31, s31, s35
    s_add_u32 s31, s31, 0
    buffer_load_dwordx4 v4, s[16:19], s31 offen lds
AT_DV_14:
    v_max3_f32 v224, v224, v91, v92
    v_max3_f32 v224, v224, v93, v94
    v_max_f32 v224, v224, v95
    v_mov_b32 v226, v224
    s_nop 1
    v_permlane32_swap_b32 v224, v226
    s_waitcnt lgkmcnt(4)
    v_mfma_f32_32x32x16_bf16 v[160:175], v[216:219], v[16:19], v[160:175]
    ds_read_b64_tr_b16 v[212:213], v3 offset:4608
    ds_read_b64_tr_b16 v[214:215], v3 offset:4736
    v_max_f32 v224, v224, v226
    v_sub_f32 v226, v224, v5
    v_mul_f32 v226, s30, v226
    v_cmp_lt_f32 vcc, s38, v226
    v_mov_b32 v227, 1.0
    s_mov_b64 s[36:37], vcc
    s_nop 3
    s_cbranch_vccz AT_NR_15
    v_max_f32 v226, v224, v5
    v_sub_f32 v227, v5, v226
    v_mul_f32 v227, s30, v227
    v_exp_f32 v227, v227
    v_mov_b32 v5, v226
AT_NR_15:
    s_waitcnt lgkmcnt(4)
    v_mfma_f32_32x32x16_bf16 v[176:191], v[220:223], v[16:19], v[176:191]
    ds_read_b64_tr_b16 v[216:217], v3 offset:8960
    ds_read_b64_tr_b16 v[218:219], v3 offset:9088
    s_cmp_eq_u32 s40, 0
    s_cbranch_scc1 AT_DV_16
    s_mul_i32 s32, s5, 1088
    s_add_u32 s32, s32, s28
    s_add_u32 m0, s32, 54528
    s_lshl_b32 s31, s5, 11
    s_add_u32 s31, s31, s35
    s_add_u32 s31, s31, 8192
    buffer_load_dwordx4 v4, s[16:19], s31 offen lds
AT_DV_16:
    v_mul_f32 v228, s30, v5
    v_fma_f32 v80, v80, s30, -v228
    v_fma_f32 v81, v81, s30, -v228
    v_fma_f32 v82, v82, s30, -v228
    v_fma_f32 v83, v83, s30, -v228
    s_waitcnt lgkmcnt(4)
    v_mfma_f32_32x32x16_bf16 v[128:143], v[208:211], v[20:23], v[128:143]
    ds_read_b64_tr_b16 v[220:221], v3 offset:13312
    ds_read_b64_tr_b16 v[222:223], v3 offset:13440
    v_fma_f32 v84, v84, s30, -v228
    v_fma_f32 v85, v85, s30, -v228
    v_fma_f32 v86, v86, s30, -v228
    v_fma_f32 v87, v87, s30, -v228
    v_fma_f32 v88, v88, s30, -v228
    s_waitcnt lgkmcnt(4)
    v_mfma_f32_32x32x16_bf16 v[144:159], v[212:215], v[20:23], v[144:159]
    ds_read_b128 v[192:195], v2 offset:34304
    s_cmp_eq_u32 s40, 0
    s_cbranch_scc1 AT_DV_17
    s_mul_i32 s32, s5, 1088
    s_add_u32 s32, s32, s28
    s_add_u32 m0, s32, 58880
    s_lshl_b32 s31, s5, 11
    s_add_u32 s31, s31, s35
    s_add_u32 s31, s31, 16384
    buffer_load_dwordx4 v4, s[16:19], s31 offen lds
AT_DV_17:
    v_fma_f32 v89, v89, s30, -v228
    v_fma_f32 v90, v90, s30, -v228
    v_fma_f32 v91, v91, s30, -v228
    v_fma_f32 v92, v92, s30, -v228
    v_fma_f32 v93, v93, s30, -v228
    s_waitcnt lgkmcnt(3)
    v_mfma_f32_32x32x16_bf16 v[160:175], v[216:219], v[20:23], v[160:175]
    ds_read_b128 v[196:199], v2 offset:36352
    v_fma_f32 v94, v94, s30, -v228
    v_fma_f32 v95, v95, s30, -v228
    v_exp_f32 v80, v80
    v_exp_f32 v81, v81
    v_exp_f32 v82, v82
    s_waitcnt lgkmcnt(2)
    v_mfma_f32_32x32x16_bf16 v[176:191], v[220:223], v[20:23], v[176:191]
    ds_read_b128 v[200:203], v2 offset:38400
    s_cmp_eq_u32 s40, 0
    s_cbranch_scc1 AT_DV_18
    s_mul_i32 s32, s5, 1088
    s_add_u32 s32, s32, s28
    s_add_u32 m0, s32, 63232
    s_lshl_b32 s31, s5, 11
    s_add_u32 s31, s31, s35
    s_add_u32 s31, s31, 24576
    buffer_load_dwordx4 v4, s[16:19], s31 offen lds
AT_DV_18:
    v_exp_f32 v83, v83
    s_waitcnt lgkmcnt(2)
    v_mfma_f32_32x32x16_bf16 v[112:127], v[192:195], v[32:35], 0
    ds_read_b128 v[204:207], v2 offset:40448
    v_exp_f32 v84, v84
    v_exp_f32 v85, v85
    v_exp_f32 v86, v86
    v_exp_f32 v87, v87
    v_exp_f32 v88, v88
    s_waitcnt lgkmcnt(2)
    v_mfma_f32_32x32x16_bf16 v[112:127], v[196:199], v[36:39], v[112:127]
    ds_read_b128 v[192:195], v2 offset:42496
    v_exp_f32 v89, v89
    v_exp_f32 v90, v90
    v_exp_f32 v91, v91
    v_exp_f32 v92, v92
    v_exp_f32 v93, v93
    s_waitcnt lgkmcnt(2)
    v_mfma_f32_32x32x16_bf16 v[112:127], v[200:203], v[40:43], v[112:127]
    ds_read_b128 v[196:199], v2 offset:44544
    v_exp_f32 v94, v94
    v_exp_f32 v95, v95
    v_add_f32 v229, v80, v84
    v_add_f32 v230, v81, v85
    v_add_f32 v231, v82, v86
    s_waitcnt lgkmcnt(2)
    v_mfma_f32_32x32x16_bf16 v[112:127], v[204:207], v[44:47], v[112:127]
    ds_read_b128 v[200:203], v2 offset:46592
    v_add_f32 v232, v83, v87
    v_add_f32 v229, v229, v88
    v_add_f32 v230, v230, v89
    v_add_f32 v231, v231, v90
    v_add_f32 v232, v232, v91
    s_waitcnt lgkmcnt(2)
    v_mfma_f32_32x32x16_bf16 v[112:127], v[192:195], v[48:51], v[112:127]
    ds_read_b128 v[204:207], v2 offset:48640
    v_add_f32 v229, v229, v92
    v_add_f32 v230, v230, v93
    v_add_f32 v231, v231, v94
    v_add_f32 v232, v232, v95
    v_cvt_pk_bf16_f32 v24, v80, v81
    s_waitcnt lgkmcnt(2)
    v_mfma_f32_32x32x16_bf16 v[112:127], v[196:199], v[52:55], v[112:127]
    ds_read_b64_tr_b16 v[208:209], v3 offset:512
    ds_read_b64_tr_b16 v[210:211], v3 offset:640
    v_cvt_pk_bf16_f32 v25, v82, v83
    v_cvt_pk_bf16_f32 v26, v84, v85
    v_cvt_pk_bf16_f32 v27, v86, v87
    v_cvt_pk_bf16_f32 v28, v88, v89
    v_cvt_pk_bf16_f32 v29, v90, v91
    s_waitcnt lgkmcnt(3)
    v_mfma_f32_32x32x16_bf16 v[112:127], v[200:203], v[56:59], v[112:127]
    ds_read_b64_tr_b16 v[212:213], v3 offset:4864
    ds_read_b64_tr_b16 v[214:215], v3 offset:4992
    v_cvt_pk_bf16_f32 v30, v92, v93
    v_cvt_pk_bf16_f32 v31, v94, v95
    v_add_f32 v229, v229, v230
    v_add_f32 v231, v231, v232
    v_add_f32 v229, v229, v231
    s_waitcnt lgkmcnt(4)
    v_mfma_f32_32x32x16_bf16 v[112:127], v[204:207], v[60:63], v[112:127]
    ds_read_b64_tr_b16 v[216:217], v3 offset:9216
    ds_read_b64_tr_b16 v[218:219], v3 offset:9344
    v_fma_f32 v6, v6, v227, v229
    s_cmp_eq_u64 s[36:37], 0
    s_cbranch_scc1 AT_RS_19
    v_mul_f32 v128, v227, v128
    v_mul_f32 v129, v227, v129
    v_mul_f32 v130, v227, v130
    v_mul_f32 v131, v227, v131
    v_mul_f32 v132, v227, v132
    v_mul_f32 v133, v227, v133
    v_mul_f32 v134, v227, v134
    v_mul_f32 v135, v227, v135
    v_mul_f32 v136, v227, v136
    v_mul_f32 v137, v227, v137
    v_mul_f32 v138, v227, v138
    v_mul_f32 v139, v227, v139
    v_mul_f32 v140, v227, v140
    v_mul_f32 v141, v227, v141
    v_mul_f32 v142, v227, v142
    v_mul_f32 v143, v227, v143
    v_mul_f32 v144, v227, v144
    v_mul_f32 v145, v227, v145
    v_mul_f32 v146, v227, v146
    v_mul_f32 v147, v227, v147
    v_mul_f32 v148, v227, v148
    v_mul_f32 v149, v227, v149
    v_mul_f32 v150, v227, v150
    v_mul_f32 v151, v227, v151
    v_mul_f32 v152, v227, v152
    v_mul_f32 v153, v227, v153
    v_mul_f32 v154, v227, v154
    v_mul_f32 v155, v227, v155
    v_mul_f32 v156, v227, v156
    v_mul_f32 v157, v227, v157
    v_mul_f32 v158, v227, v158
    v_mul_f32 v159, v227, v159
    v_mul_f32 v160, v227, v160
    v_mul_f32 v161, v227, v161
    v_mul_f32 v162, v227, v162
    v_mul_f32 v163, v227, v163
    v_mul_f32 v164, v227, v164
    v_mul_f32 v165, v227, v165
    v_mul_f32 v166, v227, v166
    v_mul_f32 v167, v227, v167
    v_mul_f32 v168, v227, v168
    v_mul_f32 v169, v227, v169
    v_mul_f32 v170, v227, v170
    v_mul_f32 v171, v227, v171
    v_mul_f32 v172, v227, v172
    v_mul_f32 v173, v227, v173
    v_mul_f32 v174, v227, v174
    v_mul_f32 v175, v227, v175
    v_mul_f32 v176, v227, v176
    v_mul_f32 v177, v227, v177
    v_mul_f32 v178, v227, v178
    v_mul_f32 v179, v227, v179
    v_mul_f32 v180, v227, v180
    v_mul_f32 v181, v227, v181
    v_mul_f32 v182, v227, v182
    v_mul_f32 v183, v227, v183
    v_mul_f32 v184, v227, v184
    v_mul_f32 v185, v227, v185
    v_mul_f32 v186, v227, v186
    v_mul_f32 v187, v227, v187
    v_mul_f32 v188, v227, v188
    v_mul_f32 v189, v227, v189
    v_mul_f32 v190, v227, v190
    v_mul_f32 v191, v227, v191
AT_RS_19:
    s_add_u32 s31, s25, 1
    s_cmp_eq_u32 s31, s24
    s_cbranch_scc0 AT_MK_20
    v_cmp_gt_i32 vcc, 0, v7
    s_nop 1
    v_cndmask_b32 v96, v96, v8, vcc
    v_cmp_gt_i32 vcc, 1, v7
    s_nop 1
    v_cndmask_b32 v97, v97, v8, vcc
    v_cmp_gt_i32 vcc, 2, v7
    s_nop 1
    v_cndmask_b32 v98, v98, v8, vcc
    v_cmp_gt_i32 vcc, 3, v7
    s_nop 1
    v_cndmask_b32 v99, v99, v8, vcc
    v_cmp_gt_i32 vcc, 8, v7
    s_nop 1
    v_cndmask_b32 v100, v100, v8, vcc
    v_cmp_gt_i32 vcc, 9, v7
    s_nop 1
    v_cndmask_b32 v101, v101, v8, vcc
    v_cmp_gt_i32 vcc, 10, v7
    s_nop 1
    v_cndmask_b32 v102, v102, v8, vcc
    v_cmp_gt_i32 vcc, 11, v7
    s_nop 1
    v_cndmask_b32 v103, v103, v8, vcc
    v_cmp_gt_i32 vcc, 16, v7
    s_nop 1
    v_cndmask_b32 v104, v104, v8, vcc
    v_cmp_gt_i32 vcc, 17, v7
    s_nop 1
    v_cndmask_b32 v105, v105, v8, vcc
    v_cmp_gt_i32 vcc, 18, v7
    s_nop 1
    v_cndmask_b32 v106, v106, v8, vcc
    v_cmp_gt_i32 vcc, 19, v7
    s_nop 1
    v_cndmask_b32 v107, v107, v8, vcc
    v_cmp_gt_i32 vcc, 24, v7
    s_nop 1
    v_cndmask_b32 v108, v108, v8, vcc
    v_cmp_gt_i32 vcc, 25, v7
    s_nop 1
    v_cndmask_b32 v109, v109, v8, vcc
    v_cmp_gt_i32 vcc, 26, v7
    s_nop 1
    v_cndmask_b32 v110, v110, v8, vcc
    v_cmp_gt_i32 vcc, 27, v7
    s_nop 1
    v_cndmask_b32 v111, v111, v8, vcc
    v_cmp_gt_i32 vcc, 32, v7
    s_nop 1
    v_cndmask_b32 v112, v112, v8, vcc
    v_cmp_gt_i32 vcc, 33, v7
    s_nop 1
    v_cndmask_b32 v113, v113, v8, vcc
    v_cmp_gt_i32 vcc, 34, v7
    s_nop 1
    v_cndmask_b32 v114, v114, v8, vcc
    v_cmp_gt_i32 vcc, 35, v7
    s_nop 1
    v_cndmask_b32 v115, v115, v8, vcc
    v_cmp_gt_i32 vcc, 40, v7
    s_nop 1
    v_cndmask_b32 v116, v116, v8, vcc
    v_cmp_gt_i32 vcc, 41, v7
    s_nop 1
    v_cndmask_b32 v117, v117, v8, vcc
    v_cmp_gt_i32 vcc, 42, v7
    s_nop 1
    v_cndmask_b32 v118, v118, v8, vcc
    v_cmp_gt_i32 vcc, 43, v7
    s_nop 1
    v_cndmask_b32 v119, v119, v8, vcc
    v_cmp_gt_i32 vcc, 48, v7
    s_nop 1
    v_cndmask_b32 v120, v120, v8, vcc
    v_cmp_gt_i32 vcc, 49, v7
    s_nop 1
    v_cndmask_b32 v121, v121, v8, vcc
    v_cmp_gt_i32 vcc, 50, v7
    s_nop 1
    v_cndmask_b32 v122, v122, v8, vcc
    v_cmp_gt_i32 vcc, 51, v7
    s_nop 1
    v_cndmask_b32 v123, v123, v8, vcc
    v_cmp_gt_i32 vcc, 56, v7
    s_nop 1
    v_cndmask_b32 v124, v124, v8, vcc
    v_cmp_gt_i32 vcc, 57, v7
    s_nop 1
    v_cndmask_b32 v125, v125, v8, vcc
    v_cmp_gt_i32 vcc, 58, v7
    s_nop 1
    v_cndmask_b32 v126, v126, v8, vcc
    v_cmp_gt_i32 vcc, 59, v7
    s_nop 1
    v_cndmask_b32 v127, v127, v8, vcc
AT_MK_20:
    s_waitcnt lgkmcnt(4)
    v_mfma_f32_32x32x16_bf16 v[128:143], v[208:211], v[24:27], v[128:143]
    ds_read_b64_tr_b16 v[220:221], v3 offset:13568
    ds_read_b64_tr_b16 v[222:223], v3 offset:13696
    v_max3_f32 v224, v96, v97, v98
    v_max3_f32 v224, v224, v99, v100
    v_max3_f32 v224, v224, v101, v102
    v_max3_f32 v224, v224, v103, v104
    v_max3_f32 v224, v224, v105, v106
    s_waitcnt lgkmcnt(4)
    v_mfma_f32_32x32x16_bf16 v[144:159], v[212:215], v[24:27], v[144:159]
    ds_read_b64_tr_b16 v[208:209], v3 offset:768
    ds_read_b64_tr_b16 v[210:211], v3 offset:896
    v_max3_f32 v224, v224, v107, v108
    v_max3_f32 v224, v224, v109, v110
    v_max_f32 v224, v224, v111
    v_mov_b32 v226, v224
    s_nop 1
    v_permlane32_swap_b32 v224, v226
    s_waitcnt lgkmcnt(4)
    v_mfma_f32_32x32x16_bf16 v[160:175], v[216:219], v[24:27], v[160:175]
    ds_read_b64_tr_b16 v[212:213], v3 offset:5120
    ds_read_b64_tr_b16 v[214:215], v3 offset:5248
    v_max_f32 v224, v224, v226
    v_sub_f32 v226, v224, v5
    v_mul_f32 v226, s30, v226
    v_cmp_lt_f32 vcc, s38, v226
    v_mov_b32 v227, 1.0
    s_mov_b64 s[36:37], vcc
    s_nop 3
    s_cbranch_vccz AT_NR_21
    v_max_f32 v226, v224, v5
    v_sub_f32 v227, v5, v226
    v_mul_f32 v227, s30, v227
    v_exp_f32 v227, v227
    v_mov_b32 v5, v226
AT_NR_21:
    s_waitcnt lgkmcnt(4)
    v_mfma_f32_32x32x16_bf16 v[176:191], v[220:223], v[24:27], v[176:191]
    ds_read_b64_tr_b16 v[216:217], v3 offset:9472
    ds_read_b64_tr_b16 v[218:219], v3 offset:9600
    v_mul_f32 v228, s30, v5
    v_fma_f32 v96, v96, s30, -v228
    v_fma_f32 v97, v97, s30, -v228
    v_fma_f32 v98, v98, s30, -v228
    v_fma_f32 v99, v99, s30, -v228
    s_waitcnt lgkmcnt(4)
    v_mfma_f32_32x32x16_bf16 v[128:143], v[208:211], v[28:31], v[128:143]
    ds_read_b64_tr_b16 v[220:221], v3 offset:13824
    ds_read_b64_tr_b16 v[222:223], v3 offset:13952
    v_fma_f32 v100, v100, s30, -v228
    v_fma_f32 v101, v101, s30, -v228
    v_fma_f32 v102, v102, s30, -v228
    v_fma_f32 v103, v103, s30, -v228
    v_fma_f32 v104, v104, s30, -v228
    s_waitcnt lgkmcnt(4)
    v_mfma_f32_32x32x16_bf16 v[144:159], v[212:215], v[28:31], v[144:159]
    v_fma_f32 v105, v105, s30, -v228
    v_fma_f32 v106, v106, s30, -v228
    v_fma_f32 v107, v107, s30, -v228
    v_fma_f32 v108, v108, s30, -v228
    v_fma_f32 v109, v109, s30, -v228
    s_waitcnt lgkmcnt(2)
    v_mfma_f32_32x32x16_bf16 v[160:175], v[216:219], v[28:31], v[160:175]
    v_fma_f32 v110, v110, s30, -v228
    v_fma_f32 v111, v111, s30, -v228
    v_exp_f32 v96, v96
    v_exp_f32 v97, v97
    v_exp_f32 v98, v98
    s_waitcnt lgkmcnt(0)
    v_mfma_f32_32x32x16_bf16 v[176:191], v[220:223], v[28:31], v[176:191]
    v_exp_f32 v99, v99
    v_exp_f32 v100, v100
    v_exp_f32 v101, v101
    s_branch AT_STN
AT_ST1:
    s_add_u32 s31, s25, 1
    s_mov_b32 s40, 1
    s_cmp_le_u32 s31, s24
    s_cbranch_scc1 AT_VT_22
    s_mov_b32 s31, 0
    s_cmp_eq_u32 s26, 0
    s_cselect_b32 s40, 1, 0
AT_VT_22:
    s_lshl_b32 s31, s31, 20
    s_add_u32 s35, s31, s29
    s_add_u32 s31, s25, 2
    s_mov_b32 s39, 1
    s_cmp_le_u32 s31, s24
    s_cbranch_scc1 AT_KT_23
    s_mov_b32 s31, 0
    s_cmp_eq_u32 s26, 0
    s_cselect_b32 s39, 1, 0
AT_KT_23:
    s_lshl_b32 s31, s31, 20
    s_add_u32 s34, s31, s29
    s_waitcnt vmcnt(0)
    s_barrier
    ds_read_b128 v[192:195], v2 offset:0
    ds_read_b128 v[196:199], v2 offset:2048
    ds_read_b128 v[200:203], v2 offset:4096
    v_exp_f32 v102, v102
    v_exp_f32 v103, v103
    v_exp_f32 v104, v104
    v_exp_f32 v105, v105
    v_exp_f32 v106, v106
    v_exp_f32 v107, v107
    s_waitcnt lgkmcnt(2)
    v_mfma_f32_32x32x16_bf16 v[64:79], v[192:195], v[32:35], 0
    ds_read_b128 v[204:207], v2 offset:6144
    v_exp_f32 v108, v108
    v_exp_f32 v109, v109
    v_exp_f32 v110, v110
    v_exp_f32 v111, v111
    v_add_f32 v229, v96, v100
    s_waitcnt lgkmcnt(2)
    v_mfma_f32_32x32x16_bf16 v[64:79], v[196:199], v[36:39], v[64:79]
    ds_read_b128 v[192:195], v2 offset:8192
    s_cmp_eq_u32 s39, 0
    s_cbranch_scc1 AT_DK_24
    s_lshl_b32 s32, s5, 10
    s_add_u32 s32, s32, s28
    s_add_u32 m0, s32, 33792
    s_lshl_b32 s31, s5, 11
    s_add_u32 s31, s31, s34
    s_add_u32 s31, s31, 0
    buffer_load_dwordx4 v4, s[12:15], s31 offen lds
AT_DK_24:
    v_add_f32 v230, v97, v101
    v_add_f32 v231, v98, v102
    v_add_f32 v232, v99, v103
    v_add_f32 v229, v229, v104
    v_add_f32 v230, v230, v105
    s_waitcnt lgkmcnt(2)
    v_mfma_f32_32x32x16_bf16 v[64:79], v[200:203], v[40:43], v[64:79]
    ds_read_b128 v[196:199], v2 offset:10240
    v_add_f32 v231, v231, v106
    v_add_f32 v232, v232, v107
    v_add_f32 v229, v229, v108
    v_add_f32 v230, v230, v109
    v_add_f32 v231, v231, v110
    s_waitcnt lgkmcnt(2)
    v_mfma_f32_32x32x16_bf16 v[64:79], v[204:207], v[44:47], v[64:79]
    ds_read_b128 v[200:203], v2 offset:12288
    s_cmp_eq_u32 s39, 0
    s_cbranch_scc1 AT_DK_25
    s_lshl_b32 s32, s5, 10
    s_add_u32 s32, s32, s28
    s_add_u32 m0, s32, 37888
    s_lshl_b32 s31, s5, 11
    s_add_u32 s31, s31, s34
    s_add_u32 s31, s31, 8192
    buffer_load_dwordx4 v4, s[12:15], s31 offen lds
AT_DK_25:
    v_add_f32 v232, v232, v111
    v_cvt_pk_bf16_f32 v16, v96, v97
    v_cvt_pk_bf16_f32 v17, v98, v99
    v_cvt_pk_bf16_f32 v18, v100, v101
    v_cvt_pk_bf16_f32 v19, v102, v103
    s_waitcnt lgkmcnt(2)
    v_mfma_f32_32x32x16_bf16 v[64:79], v[192:195], v[48:51], v[64:79]
    ds_read_b128 v[204:207], v2 offset:14336
    v_cvt_pk_bf16_f32 v20, v104, v105
    v_cvt_pk_bf16_f32 v21, v106, v107
    v_cvt_pk_bf16_f32 v22, v108, v109
    v_cvt_pk_bf16_f32 v23, v110, v111
    v_add_f32 v229, v229, v230
    s_waitcnt lgkmcnt(2)
    v_mfma_f32_32x32x16_bf16 v[64:79], v[196:199], v[52:55], v[64:79]
    ds_read_b64_tr_b16 v[208:209], v3 offset:33792
    ds_read_b64_tr_b16 v[210:211], v3 offset:33920
    s_cmp_eq_u32 s39, 0
    s_cbranch_scc1 AT_DK_26
    s_lshl_b32 s32, s5, 10
    s_add_u32 s32, s32, s28
    s_add_u32 m0, s32, 41984
    s_lshl_b32 s31, s5, 11
    s_add_u32 s31, s31, s34
    s_add_u32 s31, s31, 16384
    buffer_load_dwordx4 v4, s[12:15], s31 offen lds
AT_DK_26:
    v_add_f32 v231, v231, v232
    v_add_f32 v229, v229, v231
    v_fma_f32 v6, v6, v227, v229
    s_waitcnt lgkmcnt(3)
    v_mfma_f32_32x32x16_bf16 v[64:79], v[200:203], v[56:59], v[64:79]
    ds_read_b64_tr_b16 v[212:213], v3 offset:38144
    ds_read_b64_tr_b16 v[214:215], v3 offset:38272
    s_waitcnt lgkmcnt(4)
    v_mfma_f32_32x32x16_bf16 v[64:79], v[204:207], v[60:63], v[64:79]
    ds_read_b64_tr_b16 v[216:217], v3 offset:42496
    ds_read_b64_tr_b16 v[218:219], v3 offset:42624
    s_cmp_eq_u32 s39, 0
    s_cbranch_scc1 AT_DK_27
    s_lshl_b32 s32, s5, 10
    s_add_u32 s32, s32, s28
    s_add_u32 m0, s32, 46080
    s_lshl_b32 s31, s5, 11
    s_add_u32 s31, s31, s34
    s_add_u32 s31, s31, 24576
    buffer_load_dwordx4 v4, s[12:15], s31 offen lds
AT_DK_27:
    s_cmp_eq_u64 s[36:37], 0
    s_cbranch_scc1 AT_RS_28
    v_mul_f32 v128, v227, v128
    v_mul_f32 v129, v227, v129
    v_mul_f32 v130, v227, v130
    v_mul_f32 v131, v227, v131
    v_mul_f32 v132, v227, v132
    v_mul_f32 v133, v227, v133
    v_mul_f32 v134, v227, v134
    v_mul_f32 v135, v227, v135
    v_mul_f32 v136, v227, v136
    v_mul_f32 v137, v227, v137
    v_mul_f32 v138, v227, v138
    v_mul_f32 v139, v227, v139
    v_mul_f32 v140, v227, v140
    v_mul_f32 v141, v227, v141
    v_mul_f32 v142, v227, v142
    v_mul_f32 v143, v227, v143
    v_mul_f32 v144, v227, v144
    v_mul_f32 v145, v227, v145
    v_mul_f32 v146, v227, v146
    v_mul_f32 v147, v227, v147
    v_mul_f32 v148, v227, v148
    v_mul_f32 v149, v227, v149
    v_mul_f32 v150, v227, v150
    v_mul_f32 v151, v227, v151
    v_mul_f32 v152, v227, v152
    v_mul_f32 v153, v227, v153
    v_mul_f32 v154, v227, v154
    v_mul_f32 v155, v227, v155
    v_mul_f32 v156, v227, v156
    v_mul_f32 v157, v227, v157
    v_mul_f32 v158, v227, v158
    v_mul_f32 v159, v227, v159
    v_mul_f32 v160, v227, v160
    v_mul_f32 v161, v227, v161
    v_mul_f32 v162, v227, v162
    v_mul_f32 v163, v227, v163
    v_mul_f32 v164, v227, v164
    v_mul_f32 v165, v227, v165
    v_mul_f32 v166, v227, v166
    v_mul_f32 v167, v227, v167
    v_mul_f32 v168, v227, v168
    v_mul_f32 v169, v227, v169
    v_mul_f32 v170, v227, v170
    v_mul_f32 v171, v227, v171
    v_mul_f32 v172, v227, v172
    v_mul_f32 v173, v227, v173
    v_mul_f32 v174, v227, v174
    v_mul_f32 v175, v227, v175
    v_mul_f32 v176, v227, v176
    v_mul_f32 v177, v227, v177
    v_mul_f32 v178, v227, v178
    v_mul_f32 v179, v227, v179
    v_mul_f32 v180, v227, v180
    v_mul_f32 v181, v227, v181
    v_mul_f32 v182, v227, v182
    v_mul_f32 v183, v227, v183
    v_mul_f32 v184, v227, v184
    v_mul_f32 v185, v227, v185
    v_mul_f32 v186, v227, v186
    v_mul_f32 v187, v227, v187
    v_mul_f32 v188, v227, v188
    v_mul_f32 v189, v227, v189
    v_mul_f32 v190, v227, v190
    v_mul_f32 v191, v227, v191
AT_RS_28:
    s_waitcnt lgkmcnt(4)
    v_mfma_f32_32x32x16_bf16 v[128:143], v[208:211], v[16:19], v[128:143]
    ds_read_b64_tr_b16 v[220:221], v3 offset:46848
    ds_read_b64_tr_b16 v[222:223], v3 offset:46976
    v_max3_f32 v224, v112, v113, v114
    v_max3_f32 v224, v224, v115, v116
    v_max3_f32 v224, v224, v117, v118
    v_max3_f32 v224, v224, v119, v120
    v_max3_f32 v224, v224, v121, v122
    s_waitcnt lgkmcnt(4)
    v_mfma_f32_32x32x16_bf16 v[144:159], v[212:215], v[16:19], v[144:159]
    ds_read_b64_tr_b16 v[208:209], v3 offset:34048
    ds_read_b64_tr_b16 v[210:211], v3 offset:34176
    s_cmp_eq_u32 s40, 0
    s_cbranch_scc1 AT_DV_29
    s_mul_i32 s32, s5, 1088
    s_add_u32 s32, s32, s28
    s_add_u32 m0, s32, 16384
    s_lshl_b32 s31, s5, 11
    s_add_u32 s31, s31, s35
    s_add_u32 s31, s31, 0
    buffer_load_dwordx4 v4, s[16:19], s31 offen lds
AT_DV_29:
    v_max3_f32 v224, v224, v123, v124
    v_max3_f32 v224, v224, v125, v126
    v_max_f32 v224, v224, v127
    v_mov_b32 v226, v224
    s_nop 1
    v_permlane32_swap_b32 v224, v226
    s_waitcnt lgkmcnt(4)
    v_mfma_f32_32x32x16_bf16 v[160:175], v[216:219], v[16:19], v[160:175]
    ds_read_b64_tr_b16 v[212:213], v3 offset:38400
    ds_read_b64_tr_b16 v[214:215], v3 offset:38528
    v_max_f32 v224, v224, v226
    v_sub_f32 v226, v224, v5
    v_mul_f32 v226, s30, v226
    v_cmp_lt_f32 vcc, s38, v226
    v_mov_b32 v227, 1.0
    s_mov_b64 s[36:37], vcc
    s_nop 3
    s_cbranch_vccz AT_NR_30
    v_max_f32 v226, v224, v5
    v_sub_f32 v227, v5, v226
    v_mul_f32 v227, s30, v227
    v_exp_f32 v227, v227
    v_mov_b32 v5, v226
AT_NR_30:
    s_waitcnt lgkmcnt(4)
    v_mfma_f32_32x32x16_bf16 v[176:191], v[220:223], v[16:19], v[176:191]
    ds_read_b64_tr_b16 v[216:217], v3 offset:42752
    ds_read_b64_tr_b16 v[218:219], v3 offset:42880
    s_cmp_eq_u32 s40, 0
    s_cbranch_scc1 AT_DV_31
    s_mul_i32 s32, s5, 1088
    s_add_u32 s32, s32, s28
    s_add_u32 m0, s32, 20736
    s_lshl_b32 s31, s5, 11
    s_add_u32 s31, s31, s35
    s_add_u32 s31, s31, 8192
    buffer_load_dwordx4 v4, s[16:19], s31 offen lds
AT_DV_31:
    v_mul_f32 v228, s30, v5
    v_fma_f32 v112, v112, s30, -v228
    v_fma_f32 v113, v113, s30, -v228
    v_fma_f32 v114, v114, s30, -v228
    v_fma_f32 v115, v115, s30, -v228
    s_waitcnt lgkmcnt(4)
    v_mfma_f32_32x32x16_bf16 v[128:143], v[208:211], v[20:23], v[128:143]
    ds_read_b64_tr_b16 v[220:221], v3 offset:47104
    ds_read_b64_tr_b16 v[222:223], v3 offset:47232
    v_fma_f32 v116, v116, s30, -v228
    v_fma_f32 v117, v117, s30, -v228
    v_fma_f32 v118, v118, s30, -v228
    v_fma_f32 v119, v119, s30, -v228
    v_fma_f32 v120, v120, s30, -v228
    s_waitcnt lgkmcnt(4)
    v_mfma_f32_32x32x16_bf16 v[144:159], v[212:215], v[20:23], v[144:159]
    ds_read_b128 v[192:195], v2 offset:512
    s_cmp_eq_u32 s40, 0
    s_cbranch_scc1 AT_DV_32
    s_mul_i32 s32, s5, 1088
    s_add_u32 s32, s32, s28
    s_add_u32 m0, s32, 25088
    s_lshl_b32 s31, s5, 11
    s_add_u32 s31, s31, s35
    s_add_u32 s31, s31, 16384
    buffer_load_dwordx4 v4, s[16:19], s31 offen lds
AT_DV_32:
    v_fma_f32 v121, v121, s30, -v228
    v_fma_f32 v122, v122, s30, -v228
    v_fma_f32 v123, v123, s30, -v228
    v_fma_f32 v124, v124, s30, -v228
    v_fma_f32 v125, v125, s30, -v228
    s_waitcnt lgkmcnt(3)
    v_mfma_f32_32x32x16_bf16 v[160:175], v[216:219], v[20:23], v[160:175]
    ds_read_b128 v[196:199], v2 offset:2560
    v_fma_f32 v126, v126, s30, -v228
    v_fma_f32 v127, v127, s30, -v228
    v_exp_f32 v112, v112
    v_exp_f32 v113, v113
    v_exp_f32 v114, v114
    s_waitcnt lgkmcnt(2)
    v_mfma_f32_32x32x16_bf16 v[176:191], v[220:223], v[20:23], v[176:191]
    ds_read_b128 v[200:203], v2 offset:4608
    s_cmp_eq_u32 s40, 0
    s_cbranch_scc1 AT_DV_33
    s_mul_i32 s32, s5, 1088
    s_add_u32 s32, s32, s28
    s_add_u32 m0, s32, 29440
    s_lshl_b32 s31, s5, 11
    s_add_u32 s31, s31, s35
    s_add_u32 s31, s31, 24576
    buffer_load_dwordx4 v4, s[16:19], s31 offen lds
AT_DV_33:
    v_exp_f32 v115, v115
    s_waitcnt lgkmcnt(2)
    v_mfma_f32_32x32x16_bf16 v[80:95], v[192:195], v[32:35], 0
    ds_read_b128 v[204:207], v2 offset:6656
    v_exp_f32 v116, v116
    v_exp_f32 v117, v117
    v_exp_f32 v118, v118
    v_exp_f32 v119, v119
    v_exp_f32 v120, v120
    s_waitcnt lgkmcnt(2)
    v_mfma_f32_32x32x16_bf16 v[80:95], v[196:199], v[36:39], v[80:95]
    ds_read_b128 v[192:195], v2 offset:8704
    v_exp_f32 v121, v121
    v_exp_f32 v122, v122
    v_exp_f32 v123, v123
    v_exp_f32 v124, v124
    v_exp_f32 v125, v125
    s_waitcnt lgkmcnt(2)
    v_mfma_f32_32x32x16_bf16 v[80:95], v[200:203], v[40:43], v[80:95]
    ds_read_b128 v[196:199], v2 offset:10752
    v_exp_f32 v126, v126
    v_exp_f32 v127, v127
    v_add_f32 v229, v112, v116
    v_add_f32 v230, v113, v117
    v_add_f32 v231, v114, v118
    s_waitcnt lgkmcnt(2)
    v_mfma_f32_32x32x16_bf16 v[80:95], v[204:207], v[44:47], v[80:95]
    ds_read_b128 v[200:203], v2 offset:12800
    v_add_f32 v232, v115, v119
    v_add_f32 v229, v229, v120
    v_add_f32 v230, v230, v121
    v_add_f32 v231, v231, v122
    v_add_f32 v232, v232, v123
    s_waitcnt lgkmcnt(2)
    v_mfma_f32_32x32x16_bf16 v[80:95], v[192:195], v[48:51], v[80:95]
    ds_read_b128 v[204:207], v2 offset:14848
    v_add_f32 v229, v229, v124
    v_add_f32 v230, v230, v125
    v_add_f32 v231, v231, v126
    v_add_f32 v232, v232, v127
    v_cvt_pk_bf16_f32 v24, v112, v113
    s_waitcnt lgkmcnt(2)
    v_mfma_f32_32x32x16_bf16 v[80:95], v[196:199], v[52:55], v[80:95]
    ds_read_b64_tr_b16 v[208:209], v3 offset:34304
    ds_read_b64_tr_b16 v[210:211], v3 offset:34432
    v_cvt_pk_bf16_f32 v25, v114, v115
    v_cvt_pk_bf16_f32 v26, v116, v117
    v_cvt_pk_bf16_f32 v27, v118, v119
    v_cvt_pk_bf16_f32 v28, v120, v121
    v_cvt_pk_bf16_f32 v29, v122, v123
    s_waitcnt lgkmcnt(3)
    v_mfma_f32_32x32x16_bf16 v[80:95], v[200:203], v[56:59], v[80:95]
    ds_read_b64_tr_b16 v[212:213], v3 offset:38656
    ds_read_b64_tr_b16 v[214:215], v3 offset:38784
    v_cvt_pk_bf16_f32 v30, v124, v125
    v_cvt_pk_bf16_f32 v31, v126, v127
    v_add_f32 v229, v229, v230
    v_add_f32 v231, v231, v232
    v_add_f32 v229, v229, v231
    s_waitcnt lgkmcnt(4)
    v_mfma_f32_32x32x16_bf16 v[80:95], v[204:207], v[60:63], v[80:95]
    ds_read_b64_tr_b16 v[216:217], v3 offset:43008
    ds_read_b64_tr_b16 v[218:219], v3 offset:43136
    v_fma_f32 v6, v6, v227, v229
    s_cmp_eq_u64 s[36:37], 0
    s_cbranch_scc1 AT_RS_34
    v_mul_f32 v128, v227, v128
    v_mul_f32 v129, v227, v129
    v_mul_f32 v130, v227, v130
    v_mul_f32 v131, v227, v131
    v_mul_f32 v132, v227, v132
    v_mul_f32 v133, v227, v133
    v_mul_f32 v134, v227, v134
    v_mul_f32 v135, v227, v135
    v_mul_f32 v136, v227, v136
    v_mul_f32 v137, v227, v137
    v_mul_f32 v138, v227, v138
    v_mul_f32 v139, v227, v139
    v_mul_f32 v140, v227, v140
    v_mul_f32 v141, v227, v141
    v_mul_f32 v142, v227, v142
    v_mul_f32 v143, v227, v143
    v_mul_f32 v144, v227, v144
    v_mul_f32 v145, v227, v145
    v_mul_f32 v146, v227, v146
    v_mul_f32 v147, v227, v147
    v_mul_f32 v148, v227, v148
    v_mul_f32 v149, v227, v149
    v_mul_f32 v150, v227, v150
    v_mul_f32 v151, v227, v151
    v_mul_f32 v152, v227, v152
    v_mul_f32 v153, v227, v153
    v_mul_f32 v154, v227, v154
    v_mul_f32 v155, v227, v155
    v_mul_f32 v156, v227, v156
    v_mul_f32 v157, v227, v157
    v_mul_f32 v158, v227, v158
    v_mul_f32 v159, v227, v159
    v_mul_f32 v160, v227, v160
    v_mul_f32 v161, v227, v161
    v_mul_f32 v162, v227, v162
    v_mul_f32 v163, v227, v163
    v_mul_f32 v164, v227, v164
    v_mul_f32 v165, v227, v165
    v_mul_f32 v166, v227, v166
    v_mul_f32 v167, v227, v167
    v_mul_f32 v168, v227, v168
    v_mul_f32 v169, v227, v169
    v_mul_f32 v170, v227, v170
    v_mul_f32 v171, v227, v171
    v_mul_f32 v172, v227, v172
    v_mul_f32 v173, v227, v173
    v_mul_f32 v174, v227, v174
    v_mul_f32 v175, v227, v175
    v_mul_f32 v176, v227, v176
    v_mul_f32 v177, v227, v177
    v_mul_f32 v178, v227, v178
    v_mul_f32 v179, v227, v179
    v_mul_f32 v180, v227, v180
    v_mul_f32 v181, v227, v181
    v_mul_f32 v182, v227, v182
    v_mul_f32 v183, v227, v183
    v_mul_f32 v184, v227, v184
    v_mul_f32 v185, v227, v185
    v_mul_f32 v186, v227, v186
    v_mul_f32 v187, v227, v187
    v_mul_f32 v188, v227, v188
    v_mul_f32 v189, v227, v189
    v_mul_f32 v190, v227, v190
    v_mul_f32 v191, v227, v191
AT_RS_34:
    s_add_u32 s31, s25, 1
    s_cmp_eq_u32 s31, s24
    s_cbranch_scc0 AT_MK_35
    v_cmp_gt_i32 vcc, 0, v7
    s_nop 1
    v_cndmask_b32 v64, v64, v8, vcc
    v_cmp_gt_i32 vcc, 1, v7
    s_nop 1
    v_cndmask_b32 v65, v65, v8, vcc
    v_cmp_gt_i32 vcc, 2, v7
    s_nop 1
    v_cndmask_b32 v66, v66, v8, vcc
    v_cmp_gt_i32 vcc, 3, v7
    s_nop 1
    v_cndmask_b32 v67, v67, v8, vcc
    v_cmp_gt_i32 vcc, 8, v7
    s_nop 1
    v_cndmask_b32 v68, v68, v8, vcc
    v_cmp_gt_i32 vcc, 9, v7
    s_nop 1
    v_cndmask_b32 v69, v69, v8, vcc
    v_cmp_gt_i32 vcc, 10, v7
    s_nop 1
    v_cndmask_b32 v70, v70, v8, vcc
    v_cmp_gt_i32 vcc, 11, v7
    s_nop 1
    v_cndmask_b32 v71, v71, v8, vcc
    v_cmp_gt_i32 vcc, 16, v7
    s_nop 1
    v_cndmask_b32 v72, v72, v8, vcc
    v_cmp_gt_i32 vcc, 17, v7
    s_nop 1
    v_cndmask_b32 v73, v73, v8, vcc
    v_cmp_gt_i32 vcc, 18, v7
    s_nop 1
    v_cndmask_b32 v74, v74, v8, vcc
    v_cmp_gt_i32 vcc, 19, v7
    s_nop 1
    v_cndmask_b32 v75, v75, v8, vcc
    v_cmp_gt_i32 vcc, 24, v7
    s_nop 1
    v_cndmask_b32 v76, v76, v8, vcc
    v_cmp_gt_i32 vcc, 25, v7
    s_nop 1
    v_cndmask_b32 v77, v77, v8, vcc
    v_cmp_gt_i32 vcc, 26, v7
    s_nop 1
    v_cndmask_b32 v78, v78, v8, vcc
    v_cmp_gt_i32 vcc, 27, v7
    s_nop 1
    v_cndmask_b32 v79, v79, v8, vcc
    v_cmp_gt_i32 vcc, 32, v7
    s_nop 1
    v_cndmask_b32 v80, v80, v8, vcc
    v_cmp_gt_i32 vcc, 33, v7
    s_nop 1
    v_cndmask_b32 v81, v81, v8, vcc
    v_cmp_gt_i32 vcc, 34, v7
    s_nop 1
    v_cndmask_b32 v82, v82, v8, vcc
    v_cmp_gt_i32 vcc, 35, v7
    s_nop 1
    v_cndmask_b32 v83, v83, v8, vcc
    v_cmp_gt_i32 vcc, 40, v7
    s_nop 1
    v_cndmask_b32 v84, v84, v8, vcc
    v_cmp_gt_i32 vcc, 41, v7
    s_nop 1
    v_cndmask_b32 v85, v85, v8, vcc
    v_cmp_gt_i32 vcc, 42, v7
    s_nop 1
    v_cndmask_b32 v86, v86, v8, vcc
    v_cmp_gt_i32 vcc, 43, v7
    s_nop 1
    v_cndmask_b32 v87, v87, v8, vcc
    v_cmp_gt_i32 vcc, 48, v7
    s_nop 1
    v_cndmask_b32 v88, v88, v8, vcc
    v_cmp_gt_i32 vcc, 49, v7
    s_nop 1
    v_cndmask_b32 v89, v89, v8, vcc
    v_cmp_gt_i32 vcc, 50, v7
    s_nop 1
    v_cndmask_b32 v90, v90, v8, vcc
    v_cmp_gt_i32 vcc, 51, v7
    s_nop 1
    v_cndmask_b32 v91, v91, v8, vcc
    v_cmp_gt_i32 vcc, 56, v7
    s_nop 1
    v_cndmask_b32 v92, v92, v8, vcc
    v_cmp_gt_i32 vcc, 57, v7
    s_nop 1
    v_cndmask_b32 v93, v93, v8, vcc
    v_cmp_gt_i32 vcc, 58, v7
    s_nop 1
    v_cndmask_b32 v94, v94, v8, vcc
    v_cmp_gt_i32 vcc, 59, v7
    s_nop 1
    v_cndmask_b32 v95, v95, v8, vcc
AT_MK_35:
    s_waitcnt lgkmcnt(4)
    v_mfma_f32_32x32x16_bf16 v[128:143], v[208:211], v[24:27], v[128:143]
    ds_read_b64_tr_b16 v[220:221], v3 offset:47360
    ds_read_b64_tr_b16 v[222:223], v3 offset:47488
    v_max3_f32 v224, v64, v65, v66
    v_max3_f32 v224, v224, v67, v68
    v_max3_f32 v224, v224, v69, v70
    v_max3_f32 v224, v224, v71, v72
    v_max3_f32 v224, v224, v73, v74
    s_waitcnt lgkmcnt(4)
    v_mfma_f32_32x32x16_bf16 v[144:159], v[212:215], v[24:27], v[144:159]
    ds_read_b64_tr_b16 v[208:209], v3 offset:34560
    ds_read_b64_tr_b16 v[210:211], v3 offset:34688
    v_max3_f32 v224, v224, v75, v76
    v_max3_f32 v224, v224, v77, v78
    v_max_f32 v224, v224, v79
    v_mov_b32 v226, v224
    s_nop 1
    v_permlane32_swap_b32 v224, v226
    s_waitcnt lgkmcnt(4)
    v_mfma_f32_32x32x16_bf16 v[160:175], v[216:219], v[24:27], v[160:175]
    ds_read_b64_tr_b16 v[212:213], v3 offset:38912
    ds_read_b64_tr_b16 v[214:215], v3 offset:39040
    v_max_f32 v224, v224, v226
    v_sub_f32 v226, v224, v5
    v_mul_f32 v226, s30, v226
    v_cmp_lt_f32 vcc, s38, v226
    v_mov_b32 v227, 1.0
    s_mov_b64 s[36:37], vcc
    s_nop 3
    s_cbranch_vccz AT_NR_36
    v_max_f32 v226, v224, v5
    v_sub_f32 v227, v5, v226
    v_mul_f32 v227, s30, v227
    v_exp_f32 v227, v227
    v_mov_b32 v5, v226
AT_NR_36:
    s_waitcnt lgkmcnt(4)
    v_mfma_f32_32x32x16_bf16 v[176:191], v[220:223], v[24:27], v[176:191]
    ds_read_b64_tr_b16 v[216:217], v3 offset:43264
    ds_read_b64_tr_b16 v[218:219], v3 offset:43392
    v_mul_f32 v228, s30, v5
    v_fma_f32 v64, v64, s30, -v228
    v_fma_f32 v65, v65, s30, -v228
    v_fma_f32 v66, v66, s30, -v228
    v_fma_f32 v67, v67, s30, -v228
    s_waitcnt lgkmcnt(4)
    v_mfma_f32_32x32x16_bf16 v[128:143], v[208:211], v[28:31], v[128:143]
    ds_read_b64_tr_b16 v[220:221], v3 offset:47616
    ds_read_b64_tr_b16 v[222:223], v3 offset:47744
    v_fma_f32 v68, v68, s30, -v228
    v_fma_f32 v69, v69, s30, -v228
    v_fma_f32 v70, v70, s30, -v228
    v_fma_f32 v71, v71, s30, -v228
    v_fma_f32 v72, v72, s30, -v228
    s_waitcnt lgkmcnt(4)
    v_mfma_f32_32x32x16_bf16 v[144:159], v[212:215], v[28:31], v[144:159]
    v_fma_f32 v73, v73, s30, -v228
    v_fma_f32 v74, v74, s30, -v228
    v_fma_f32 v75, v75, s30, -v228
    v_fma_f32 v76, v76, s30, -v228
    v_fma_f32 v77, v77, s30, -v228
    s_waitcnt lgkmcnt(2)
    v_mfma_f32_32x32x16_bf16 v[160:175], v[216:219], v[28:31], v[160:175]
    v_fma_f32 v78, v78, s30, -v228
    v_fma_f32 v79, v79, s30, -v228
    v_exp_f32 v64, v64
    v_exp_f32 v65, v65
    v_exp_f32 v66, v66
    s_waitcnt lgkmcnt(0)
    v_mfma_f32_32x32x16_bf16 v[176:191], v[220:223], v[28:31], v[176:191]
    v_exp_f32 v67, v67
    v_exp_f32 v68, v68
    v_exp_f32 v69, v69
AT_STN:
    s_xor_b32 s27, s27, 1
    s_add_u32 s25, s25, 1
    s_branch AT_ITER
AT_TAIL:
    s_cmp_eq_u32 s27, 0
    s_cbranch_scc0 AT_TL1
    s_add_u32 s31, s25, 1
    s_mov_b32 s40, 1
    s_cmp_le_u32 s31, s24
    s_cbranch_scc1 AT_VT_37
    s_mov_b32 s31, 0
    s_cmp_eq_u32 s26, 0
    s_cselect_b32 s40, 1, 0
AT_VT_37:
    s_lshl_b32 s31, s31, 20
    s_add_u32 s35, s31, s29
    s_mov_b32 s39, 0
    s_waitcnt vmcnt(0)
    s_barrier
    v_exp_f32 v70, v70
    v_exp_f32 v71, v71
    v_exp_f32 v72, v72
    v_exp_f32 v73, v73
    v_exp_f32 v74, v74
    v_exp_f32 v75, v75
    v_exp_f32 v76, v76
    v_exp_f32 v77, v77
    v_exp_f32 v78, v78
    v_exp_f32 v79, v79
    v_add_f32 v229, v64, v68
    v_add_f32 v230, v65, v69
    v_add_f32 v231, v66, v70
    v_add_f32 v232, v67, v71
    v_add_f32 v229, v229, v72
    v_add_f32 v230, v230, v73
    v_add_f32 v231, v231, v74
    v_add_f32 v232, v232, v75
    v_add_f32 v229, v229, v76
    v_add_f32 v230, v230, v77
    v_add_f32 v231, v231, v78
    v_add_f32 v232, v232, v79
    v_cvt_pk_bf16_f32 v16, v64, v65
    v_cvt_pk_bf16_f32 v17, v66, v67
    v_cvt_pk_bf16_f32 v18, v68, v69
    v_cvt_pk_bf16_f32 v19, v70, v71
    v_cvt_pk_bf16_f32 v20, v72, v73
    v_cvt_pk_bf16_f32 v21, v74, v75
    v_cvt_pk_bf16_f32 v22, v76, v77
    v_cvt_pk_bf16_f32 v23, v78, v79
    v_add_f32 v229, v229, v230
    v_add_f32 v231, v231, v232
    v_add_f32 v229, v229, v231
    v_fma_f32 v6, v6, v227, v229
    s_cmp_eq_u64 s[36:37], 0
    s_cbranch_scc1 AT_RS_38
    v_mul_f32 v128, v227, v128
    v_mul_f32 v129, v227, v129
    v_mul_f32 v130, v227, v130
    v_mul_f32 v131, v227, v131
    v_mul_f32 v132, v227, v132
    v_mul_f32 v133, v227, v133
    v_mul_f32 v134, v227, v134
    v_mul_f32 v135, v227, v135
    v_mul_f32 v136, v227, v136
    v_mul_f32 v137, v227, v137
    v_mul_f32 v138, v227, v138
    v_mul_f32 v139, v227, v139
    v_mul_f32 v140, v227, v140
    v_mul_f32 v141, v227, v141
    v_mul_f32 v142, v227, v142
    v_mul_f32 v143, v227, v143
    v_mul_f32 v144, v227, v144
    v_mul_f32 v145, v227, v145
    v_mul_f32 v146, v227, v146
    v_mul_f32 v147, v227, v147
    v_mul_f32 v148, v227, v148
    v_mul_f32 v149, v227, v149
    v_mul_f32 v150, v227, v150
    v_mul_f32 v151, v227, v151
    v_mul_f32 v152, v227, v152
    v_mul_f32 v153, v227, v153
    v_mul_f32 v154, v227, v154
    v_mul_f32 v155, v227, v155
    v_mul_f32 v156, v227, v156
    v_mul_f32 v157, v227, v157
    v_mul_f32 v158, v227, v158
    v_mul_f32 v159, v227, v159
    v_mul_f32 v160, v227, v160
    v_mul_f32 v161, v227, v161
    v_mul_f32 v162, v227, v162
    v_mul_f32 v163, v227, v163
    v_mul_f32 v164, v227, v164
    v_mul_f32 v165, v227, v165
    v_mul_f32 v166, v227, v166
    v_mul_f32 v167, v227, v167
    v_mul_f32 v168, v227, v168
    v_mul_f32 v169, v227, v169
    v_mul_f32 v170, v227, v170
    v_mul_f32 v171, v227, v171
    v_mul_f32 v172, v227, v172
    v_mul_f32 v173, v227, v173
    v_mul_f32 v174, v227, v174
    v_mul_f32 v175, v227, v175
    v_mul_f32 v176, v227, v176
    v_mul_f32 v177, v227, v177
    v_mul_f32 v178, v227, v178
    v_mul_f32 v179, v227, v179
    v_mul_f32 v180, v227, v180
    v_mul_f32 v181, v227, v181
    v_mul_f32 v182, v227, v182
    v_mul_f32 v183, v227, v183
    v_mul_f32 v184, v227, v184
    v_mul_f32 v185, v227, v185
    v_mul_f32 v186, v227, v186
    v_mul_f32 v187, v227, v187
    v_mul_f32 v188, v227, v188
    v_mul_f32 v189, v227, v189
    v_mul_f32 v190, v227, v190
    v_mul_f32 v191, v227, v191
AT_RS_38:
    ds_read_b64_tr_b16 v[208:209], v3 offset:0
    ds_read_b64_tr_b16 v[210:211], v3 offset:128
    ds_read_b64_tr_b16 v[212:213], v3 offset:4352
    ds_read_b64_tr_b16 v[214:215], v3 offset:4480
    ds_read_b64_tr_b16 v[216:217], v3 offset:8704
    ds_read_b64_tr_b16 v[218:219], v3 offset:8832
    s_waitcnt lgkmcnt(4)
    v_mfma_f32_32x32x16_bf16 v[128:143], v[208:211], v[16:19], v[128:143]
    ds_read_b64_tr_b16 v[220:221], v3 offset:13056
    ds_read_b64_tr_b16 v[222:223], v3 offset:13184
    v_max3_f32 v224, v80, v81, v82
    v_max3_f32 v224, v224, v83, v84
    v_max3_f32 v224, v224, v85, v86
    v_max3_f32 v224, v224, v87, v88
    v_max3_f32 v224, v224, v89, v90
    v_max3_f32 v224, v224, v91, v92
    v_max3_f32 v224, v224, v93, v94
    v_max_f32 v224, v224, v95
    v_mov_b32 v226, v224
    s_nop 1
    v_permlane32_swap_b32 v224, v226
    s_waitcnt lgkmcnt(4)
    v_mfma_f32_32x32x16_bf16 v[144:159], v[212:215], v[16:19], v[144:159]
    ds_read_b64_tr_b16 v[208:209], v3 offset:256
    ds_read_b64_tr_b16 v[210:211], v3 offset:384
    s_cmp_eq_u32 s40, 0
    s_cbranch_scc1 AT_DV_39
    s_mul_i32 s32, s5, 1088
    s_add_u32 s32, s32, s28
    s_add_u32 m0, s32, 50176
    s_lshl_b32 s31, s5, 11
    s_add_u32 s31, s31, s35
    s_add_u32 s31, s31, 0
    buffer_load_dwordx4 v4, s[16:19], s31 offen lds
AT_DV_39:
    v_max_f32 v224, v224, v226
    v_sub_f32 v226, v224, v5
    v_mul_f32 v226, s30, v226
    v_cmp_lt_f32 vcc, s38, v226
    v_mov_b32 v227, 1.0
    s_mov_b64 s[36:37], vcc
    s_nop 3
    s_cbranch_vccz AT_NR_40
    v_max_f32 v226, v224, v5
    v_sub_f32 v227, v5, v226
    v_mul_f32 v227, s30, v227
    v_exp_f32 v227, v227
    v_mov_b32 v5, v226
AT_NR_40:
    v_mul_f32 v228, s30, v5
    v_fma_f32 v80, v80, s30, -v228
    v_fma_f32 v81, v81, s30, -v228
    v_fma_f32 v82, v82, s30, -v228
    v_fma_f32 v83, v83, s30, -v228
    s_waitcnt lgkmcnt(4)
    v_mfma_f32_32x32x16_bf16 v[160:175], v[216:219], v[16:19], v[160:175]
    ds_read_b64_tr_b16 v[212:213], v3 offset:4608
    ds_read_b64_tr_b16 v[214:215], v3 offset:4736
    v_fma_f32 v84, v84, s30, -v228
    v_fma_f32 v85, v85, s30, -v228
    v_fma_f32 v86, v86, s30, -v228
    v_fma_f32 v87, v87, s30, -v228
    v_fma_f32 v88, v88, s30, -v228
    v_fma_f32 v89, v89, s30, -v228
    v_fma_f32 v90, v90, s30, -v228
    v_fma_f32 v91, v91, s30, -v228
    v_fma_f32 v92, v92, s30, -v228
    v_fma_f32 v93, v93, s30, -v228
    s_waitcnt lgkmcnt(4)
    v_mfma_f32_32x32x16_bf16 v[176:191], v[220:223], v[16:19], v[176:191]
    ds_read_b64_tr_b16 v[216:217], v3 offset:8960
    ds_read_b64_tr_b16 v[218:219], v3 offset:9088
    s_cmp_eq_u32 s40, 0
    s_cbranch_scc1 AT_DV_41
    s_mul_i32 s32, s5, 1088
    s_add_u32 s32, s32, s28
    s_add_u32 m0, s32, 54528
    s_lshl_b32 s31, s5, 11
    s_add_u32 s31, s31, s35
    s_add_u32 s31, s31, 8192
    buffer_load_dwordx4 v4, s[16:19], s31 offen lds
AT_DV_41:
    v_fma_f32 v94, v94, s30, -v228
    v_fma_f32 v95, v95, s30, -v228
    v_exp_f32 v80, v80
    v_exp_f32 v81, v81
    v_exp_f32 v82, v82
    v_exp_f32 v83, v83
    v_exp_f32 v84, v84
    v_exp_f32 v85, v85
    v_exp_f32 v86, v86
    v_exp_f32 v87, v87
    s_waitcnt lgkmcnt(4)
    v_mfma_f32_32x32x16_bf16 v[128:143], v[208:211], v[20:23], v[128:143]
    ds_read_b64_tr_b16 v[220:221], v3 offset:13312
    ds_read_b64_tr_b16 v[222:223], v3 offset:13440
    v_exp_f32 v88, v88
    v_exp_f32 v89, v89
    v_exp_f32 v90, v90
    v_exp_f32 v91, v91
    v_exp_f32 v92, v92
    v_exp_f32 v93, v93
    v_exp_f32 v94, v94
    v_exp_f32 v95, v95
    v_add_f32 v229, v80, v84
    v_add_f32 v230, v81, v85
    s_waitcnt lgkmcnt(4)
    v_mfma_f32_32x32x16_bf16 v[144:159], v[212:215], v[20:23], v[144:159]
    ds_read_b64_tr_b16 v[208:209], v3 offset:512
    ds_read_b64_tr_b16 v[210:211], v3 offset:640
    s_cmp_eq_u32 s40, 0
    s_cbranch_scc1 AT_DV_42
    s_mul_i32 s32, s5, 1088
    s_add_u32 s32, s32, s28
    s_add_u32 m0, s32, 58880
    s_lshl_b32 s31, s5, 11
    s_add_u32 s31, s31, s35
    s_add_u32 s31, s31, 16384
    buffer_load_dwordx4 v4, s[16:19], s31 offen lds
AT_DV_42:
    v_add_f32 v231, v82, v86
    v_add_f32 v232, v83, v87
    v_add_f32 v229, v229, v88
    v_add_f32 v230, v230, v89
    v_add_f32 v231, v231, v90
    v_add_f32 v232, v232, v91
    v_add_f32 v229, v229, v92
    v_add_f32 v230, v230, v93
    v_add_f32 v231, v231, v94
    v_add_f32 v232, v232, v95
    s_waitcnt lgkmcnt(4)
    v_mfma_f32_32x32x16_bf16 v[160:175], v[216:219], v[20:23], v[160:175]
    ds_read_b64_tr_b16 v[212:213], v3 offset:4864
    ds_read_b64_tr_b16 v[214:215], v3 offset:4992
    v_cvt_pk_bf16_f32 v24, v80, v81
    v_cvt_pk_bf16_f32 v25, v82, v83
    v_cvt_pk_bf16_f32 v26, v84, v85
    v_cvt_pk_bf16_f32 v27, v86, v87
    v_cvt_pk_bf16_f32 v28, v88, v89
    v_cvt_pk_bf16_f32 v29, v90, v91
    v_cvt_pk_bf16_f32 v30, v92, v93
    v_cvt_pk_bf16_f32 v31, v94, v95
    v_add_f32 v229, v229, v230
    v_add_f32 v231, v231, v232
    s_waitcnt lgkmcnt(4)
    v_mfma_f32_32x32x16_bf16 v[176:191], v[220:223], v[20:23], v[176:191]
    ds_read_b64_tr_b16 v[216:217], v3 offset:9216
    ds_read_b64_tr_b16 v[218:219], v3 offset:9344
    s_cmp_eq_u32 s40, 0
    s_cbranch_scc1 AT_DV_43
    s_mul_i32 s32, s5, 1088
    s_add_u32 s32, s32, s28
    s_add_u32 m0, s32, 63232
    s_lshl_b32 s31, s5, 11
    s_add_u32 s31, s31, s35
    s_add_u32 s31, s31, 24576
    buffer_load_dwordx4 v4, s[16:19], s31 offen lds
AT_DV_43:
    v_add_f32 v229, v229, v231
    v_fma_f32 v6, v6, v227, v229
    s_cmp_eq_u64 s[36:37], 0
    s_cbranch_scc1 AT_RS_44
    v_mul_f32 v128, v227, v128
    v_mul_f32 v129, v227, v129
    v_mul_f32 v130, v227, v130
    v_mul_f32 v131, v227, v131
    v_mul_f32 v132, v227, v132
    v_mul_f32 v133, v227, v133
    v_mul_f32 v134, v227, v134
    v_mul_f32 v135, v227, v135
    v_mul_f32 v136, v227, v136
    v_mul_f32 v137, v227, v137
    v_mul_f32 v138, v227, v138
    v_mul_f32 v139, v227, v139
    v_mul_f32 v140, v227, v140
    v_mul_f32 v141, v227, v141
    v_mul_f32 v142, v227, v142
    v_mul_f32 v143, v227, v143
    v_mul_f32 v144, v227, v144
    v_mul_f32 v145, v227, v145
    v_mul_f32 v146, v227, v146
    v_mul_f32 v147, v227, v147
    v_mul_f32 v148, v227, v148
    v_mul_f32 v149, v227, v149
    v_mul_f32 v150, v227, v150
    v_mul_f32 v151, v227, v151
    v_mul_f32 v152, v227, v152
    v_mul_f32 v153, v227, v153
    v_mul_f32 v154, v227, v154
    v_mul_f32 v155, v227, v155
    v_mul_f32 v156, v227, v156
    v_mul_f32 v157, v227, v157
    v_mul_f32 v158, v227, v158
    v_mul_f32 v159, v227, v159
    v_mul_f32 v160, v227, v160
    v_mul_f32 v161, v227, v161
    v_mul_f32 v162, v227, v162
    v_mul_f32 v163, v227, v163
    v_mul_f32 v164, v227, v164
    v_mul_f32 v165, v227, v165
    v_mul_f32 v166, v227, v166
    v_mul_f32 v167, v227, v167
    v_mul_f32 v168, v227, v168
    v_mul_f32 v169, v227, v169
    v_mul_f32 v170, v227, v170
    v_mul_f32 v171, v227, v171
    v_mul_f32 v172, v227, v172
    v_mul_f32 v173, v227, v173
    v_mul_f32 v174, v227, v174
    v_mul_f32 v175, v227, v175
    v_mul_f32 v176, v227, v176
    v_mul_f32 v177, v227, v177
    v_mul_f32 v178, v227, v178
    v_mul_f32 v179, v227, v179
    v_mul_f32 v180, v227, v180
    v_mul_f32 v181, v227, v181
    v_mul_f32 v182, v227, v182
    v_mul_f32 v183, v227, v183
    v_mul_f32 v184, v227, v184
    v_mul_f32 v185, v227, v185
    v_mul_f32 v186, v227, v186
    v_mul_f32 v187, v227, v187
    v_mul_f32 v188, v227, v188
    v_mul_f32 v189, v227, v189
    v_mul_f32 v190, v227, v190
    v_mul_f32 v191, v227, v191
AT_RS_44:
    s_waitcnt lgkmcnt(4)
    v_mfma_f32_32x32x16_bf16 v[128:143], v[208:211], v[24:27], v[128:143]
    ds_read_b64_tr_b16 v[220:221], v3 offset:13568
    ds_read_b64_tr_b16 v[222:223], v3 offset:13696
    s_waitcnt lgkmcnt(4)
    v_mfma_f32_32x32x16_bf16 v[144:159], v[212:215], v[24:27], v[144:159]
    ds_read_b64_tr_b16 v[208:209], v3 offset:768
    ds_read_b64_tr_b16 v[210:211], v3 offset:896
    s_waitcnt lgkmcnt(4)
    v_mfma_f32_32x32x16_bf16 v[160:175], v[216:219], v[24:27], v[160:175]
    ds_read_b64_tr_b16 v[212:213], v3 offset:5120
    ds_read_b64_tr_b16 v[214:215], v3 offset:5248
    s_waitcnt lgkmcnt(4)
    v_mfma_f32_32x32x16_bf16 v[176:191], v[220:223], v[24:27], v[176:191]
    ds_read_b64_tr_b16 v[216:217], v3 offset:9472
    ds_read_b64_tr_b16 v[218:219], v3 offset:9600
    s_waitcnt lgkmcnt(4)
    v_mfma_f32_32x32x16_bf16 v[128:143], v[208:211], v[28:31], v[128:143]
    ds_read_b64_tr_b16 v[220:221], v3 offset:13824
    ds_read_b64_tr_b16 v[222:223], v3 offset:13952
    s_waitcnt lgkmcnt(4)
    v_mfma_f32_32x32x16_bf16 v[144:159], v[212:215], v[28:31], v[144:159]
    s_waitcnt lgkmcnt(2)
    v_mfma_f32_32x32x16_bf16 v[160:175], v[216:219], v[28:31], v[160:175]
    s_waitcnt lgkmcnt(0)
    v_mfma_f32_32x32x16_bf16 v[176:191], v[220:223], v[28:31], v[176:191]
    s_branch AT_TLN
AT_TL1:
    s_add_u32 s31, s25, 1
    s_mov_b32 s40, 1
    s_cmp_le_u32 s31, s24
    s_cbranch_scc1 AT_VT_45
    s_mov_b32 s31, 0
    s_cmp_eq_u32 s26, 0
    s_cselect_b32 s40, 1, 0
AT_VT_45:
    s_lshl_b32 s31, s31, 20
    s_add_u32 s35, s31, s29
    s_mov_b32 s39, 0
    s_waitcnt vmcnt(0)
    s_barrier
    v_exp_f32 v102, v102
    v_exp_f32 v103, v103
    v_exp_f32 v104, v104
    v_exp_f32 v105, v105
    v_exp_f32 v106, v106
    v_exp_f32 v107, v107
    v_exp_f32 v108, v108
    v_exp_f32 v109, v109
    v_exp_f32 v110, v110
    v_exp_f32 v111, v111
    v_add_f32 v229, v96, v100
    v_add_f32 v230, v97, v101
    v_add_f32 v231, v98, v102
    v_add_f32 v232, v99, v103
    v_add_f32 v229, v229, v104
    v_add_f32 v230, v230, v105
    v_add_f32 v231, v231, v106
    v_add_f32 v232, v232, v107
    v_add_f32 v229, v229, v108
    v_add_f32 v230, v230, v109
    v_add_f32 v231, v231, v110
    v_add_f32 v232, v232, v111
    v_cvt_pk_bf16_f32 v16, v96, v97
    v_cvt_pk_bf16_f32 v17, v98, v99
    v_cvt_pk_bf16_f32 v18, v100, v101
    v_cvt_pk_bf16_f32 v19, v102, v103
    v_cvt_pk_bf16_f32 v20, v104, v105
    v_cvt_pk_bf16_f32 v21, v106, v107
    v_cvt_pk_bf16_f32 v22, v108, v109
    v_cvt_pk_bf16_f32 v23, v110, v111
    v_add_f32 v229, v229, v230
    v_add_f32 v231, v231, v232
    v_add_f32 v229, v229, v231
    v_fma_f32 v6, v6, v227, v229
    s_cmp_eq_u64 s[36:37], 0
    s_cbranch_scc1 AT_RS_46
    v_mul_f32 v128, v227, v128
    v_mul_f32 v129, v227, v129
    v_mul_f32 v130, v227, v130
    v_mul_f32 v131, v227, v131
    v_mul_f32 v132, v227, v132
    v_mul_f32 v133, v227, v133
    v_mul_f32 v134, v227, v134
    v_mul_f32 v135, v227, v135
    v_mul_f32 v136, v227, v136
    v_mul_f32 v137, v227, v137
    v_mul_f32 v138, v227, v138
    v_mul_f32 v139, v227, v139
    v_mul_f32 v140, v227, v140
    v_mul_f32 v141, v227, v141
    v_mul_f32 v142, v227, v142
    v_mul_f32 v143, v227, v143
    v_mul_f32 v144, v227, v144
    v_mul_f32 v145, v227, v145
    v_mul_f32 v146, v227, v146
    v_mul_f32 v147, v227, v147
    v_mul_f32 v148, v227, v148
    v_mul_f32 v149, v227, v149
    v_mul_f32 v150, v227, v150
    v_mul_f32 v151, v227, v151
    v_mul_f32 v152, v227, v152
    v_mul_f32 v153, v227, v153
    v_mul_f32 v154, v227, v154
    v_mul_f32 v155, v227, v155
    v_mul_f32 v156, v227, v156
    v_mul_f32 v157, v227, v157
    v_mul_f32 v158, v227, v158
    v_mul_f32 v159, v227, v159
    v_mul_f32 v160, v227, v160
    v_mul_f32 v161, v227, v161
    v_mul_f32 v162, v227, v162
    v_mul_f32 v163, v227, v163
    v_mul_f32 v164, v227, v164
    v_mul_f32 v165, v227, v165
    v_mul_f32 v166, v227, v166
    v_mul_f32 v167, v227, v167
    v_mul_f32 v168, v227, v168
    v_mul_f32 v169, v227, v169
    v_mul_f32 v170, v227, v170
    v_mul_f32 v171, v227, v171
    v_mul_f32 v172, v227, v172
    v_mul_f32 v173, v227, v173
    v_mul_f32 v174, v227, v174
    v_mul_f32 v175, v227, v175
    v_mul_f32 v176, v227, v176
    v_mul_f32 v177, v227, v177
    v_mul_f32 v178, v227, v178
    v_mul_f32 v179, v227, v179
    v_mul_f32 v180, v227, v180
    v_mul_f32 v181, v227, v181
    v_mul_f32 v182, v227, v182
    v_mul_f32 v183, v227, v183
    v_mul_f32 v184, v227, v184
    v_mul_f32 v185, v227, v185
    v_mul_f32 v186, v227, v186
    v_mul_f32 v187, v227, v187
    v_mul_f32 v188, v227, v188
    v_mul_f32 v189, v227, v189
    v_mul_f32 v190, v227, v190
    v_mul_f32 v191, v227, v191
AT_RS_46:
    ds_read_b64_tr_b16 v[208:209], v3 offset:33792
    ds_read_b64_tr_b16 v[210:211], v3 offset:33920
    ds_read_b64_tr_b16 v[212:213], v3 offset:38144
    ds_read_b64_tr_b16 v[214:215], v3 offset:38272
    ds_read_b64_tr_b16 v[216:217], v3 offset:42496
    ds_read_b64_tr_b16 v[218:219], v3 offset:42624
    s_waitcnt lgkmcnt(4)
    v_mfma_f32_32x32x16_bf16 v[128:143], v[208:211], v[16:19], v[128:143]
    ds_read_b64_tr_b16 v[220:221], v3 offset:46848
    ds_read_b64_tr_b16 v[222:223], v3 offset:46976
    v_max3_f32 v224, v112, v113, v114
    v_max3_f32 v224, v224, v115, v116
    v_max3_f32 v224, v224, v117, v118
    v_max3_f32 v224, v224, v119, v120
    v_max3_f32 v224, v224, v121, v122
    v_max3_f32 v224, v224, v123, v124
    v_max3_f32 v224, v224, v125, v126
    v_max_f32 v224, v224, v127
    v_mov_b32 v226, v224
    s_nop 1
    v_permlane32_swap_b32 v224, v226
    s_waitcnt lgkmcnt(4)
    v_mfma_f32_32x32x16_bf16 v[144:159], v[212:215], v[16:19], v[144:159]
    ds_read_b64_tr_b16 v[208:209], v3 offset:34048
    ds_read_b64_tr_b16 v[210:211], v3 offset:34176
    s_cmp_eq_u32 s40, 0
    s_cbranch_scc1 AT_DV_47
    s_mul_i32 s32, s5, 1088
    s_add_u32 s32, s32, s28
    s_add_u32 m0, s32, 16384
    s_lshl_b32 s31, s5, 11
    s_add_u32 s31, s31, s35
    s_add_u32 s31, s31, 0
    buffer_load_dwordx4 v4, s[16:19], s31 offen lds
AT_DV_47:
    v_max_f32 v224, v224, v226
    v_sub_f32 v226, v224, v5
    v_mul_f32 v226, s30, v226
    v_cmp_lt_f32 vcc, s38, v226
    v_mov_b32 v227, 1.0
    s_mov_b64 s[36:37], vcc
    s_nop 3
    s_cbranch_vccz AT_NR_48
    v_max_f32 v226, v224, v5
    v_sub_f32 v227, v5, v226
    v_mul_f32 v227, s30, v227
    v_exp_f32 v227, v227
    v_mov_b32 v5, v226
AT_NR_48:
    v_mul_f32 v228, s30, v5
    v_fma_f32 v112, v112, s30, -v228
    v_fma_f32 v113, v113, s30, -v228
    v_fma_f32 v114, v114, s30, -v228
    v_fma_f32 v115, v115, s30, -v228
    s_waitcnt lgkmcnt(4)
    v_mfma_f32_32x32x16_bf16 v[160:175], v[216:219], v[16:19], v[160:175]
    ds_read_b64_tr_b16 v[212:213], v3 offset:38400
    ds_read_b64_tr_b16 v[214:215], v3 offset:38528
    v_fma_f32 v116, v116, s30, -v228
    v_fma_f32 v117, v117, s30, -v228
    v_fma_f32 v118, v118, s30, -v228
    v_fma_f32 v119, v119, s30, -v228
    v_fma_f32 v120, v120, s30, -v228
    v_fma_f32 v121, v121, s30, -v228
    v_fma_f32 v122, v122, s30, -v228
    v_fma_f32 v123, v123, s30, -v228
    v_fma_f32 v124, v124, s30, -v228
    v_fma_f32 v125, v125, s30, -v228
    s_waitcnt lgkmcnt(4)
    v_mfma_f32_32x32x16_bf16 v[176:191], v[220:223], v[16:19], v[176:191]
    ds_read_b64_tr_b16 v[216:217], v3 offset:42752
    ds_read_b64_tr_b16 v[218:219], v3 offset:42880
    s_cmp_eq_u32 s40, 0
    s_cbranch_scc1 AT_DV_49
    s_mul_i32 s32, s5, 1088
    s_add_u32 s32, s32, s28
    s_add_u32 m0, s32, 20736
    s_lshl_b32 s31, s5, 11
    s_add_u32 s31, s31, s35
    s_add_u32 s31, s31, 8192
    buffer_load_dwordx4 v4, s[16:19], s31 offen lds
AT_DV_49:
    v_fma_f32 v126, v126, s30, -v228
    v_fma_f32 v127, v127, s30, -v228
    v_exp_f32 v112, v112
    v_exp_f32 v113, v113
    v_exp_f32 v114, v114
    v_exp_f32 v115, v115
    v_exp_f32 v116, v116
    v_exp_f32 v117, v117
    v_exp_f32 v118, v118
    v_exp_f32 v119, v119
    s_waitcnt lgkmcnt(4)
    v_mfma_f32_32x32x16_bf16 v[128:143], v[208:211], v[20:23], v[128:143]
    ds_read_b64_tr_b16 v[220:221], v3 offset:47104
    ds_read_b64_tr_b16 v[222:223], v3 offset:47232
    v_exp_f32 v120, v120
    v_exp_f32 v121, v121
    v_exp_f32 v122, v122
    v_exp_f32 v123, v123
    v_exp_f32 v124, v124
    v_exp_f32 v125, v125
    v_exp_f32 v126, v126
    v_exp_f32 v127, v127
    v_add_f32 v229, v112, v116
    v_add_f32 v230, v113, v117
    s_waitcnt lgkmcnt(4)
    v_mfma_f32_32x32x16_bf16 v[144:159], v[212:215], v[20:23], v[144:159]
    ds_read_b64_tr_b16 v[208:209], v3 offset:34304
    ds_read_b64_tr_b16 v[210:211], v3 offset:34432
    s_cmp_eq_u32 s40, 0
    s_cbranch_scc1 AT_DV_50
    s_mul_i32 s32, s5, 1088
    s_add_u32 s32, s32, s28
    s_add_u32 m0, s32, 25088
    s_lshl_b32 s31, s5, 11
    s_add_u32 s31, s31, s35
    s_add_u32 s31, s31, 16384
    buffer_load_dwordx4 v4, s[16:19], s31 offen lds
AT_DV_50:
    v_add_f32 v231, v114, v118
    v_add_f32 v232, v115, v119
    v_add_f32 v229, v229, v120
    v_add_f32 v230, v230, v121
    v_add_f32 v231, v231, v122
    v_add_f32 v232, v232, v123
    v_add_f32 v229, v229, v124
    v_add_f32 v230, v230, v125
    v_add_f32 v231, v231, v126
    v_add_f32 v232, v232, v127
    s_waitcnt lgkmcnt(4)
    v_mfma_f32_32x32x16_bf16 v[160:175], v[216:219], v[20:23], v[160:175]
    ds_read_b64_tr_b16 v[212:213], v3 offset:38656
    ds_read_b64_tr_b16 v[214:215], v3 offset:38784
    v_cvt_pk_bf16_f32 v24, v112, v113
    v_cvt_pk_bf16_f32 v25, v114, v115
    v_cvt_pk_bf16_f32 v26, v116, v117
    v_cvt_pk_bf16_f32 v27, v118, v119
    v_cvt_pk_bf16_f32 v28, v120, v121
    v_cvt_pk_bf16_f32 v29, v122, v123
    v_cvt_pk_bf16_f32 v30, v124, v125
    v_cvt_pk_bf16_f32 v31, v126, v127
    v_add_f32 v229, v229, v230
    v_add_f32 v231, v231, v232
    s_waitcnt lgkmcnt(4)
    v_mfma_f32_32x32x16_bf16 v[176:191], v[220:223], v[20:23], v[176:191]
    ds_read_b64_tr_b16 v[216:217], v3 offset:43008
    ds_read_b64_tr_b16 v[218:219], v3 offset:43136
    s_cmp_eq_u32 s40, 0
    s_cbranch_scc1 AT_DV_51
    s_mul_i32 s32, s5, 1088
    s_add_u32 s32, s32, s28
    s_add_u32 m0, s32, 29440
    s_lshl_b32 s31, s5, 11
    s_add_u32 s31, s31, s35
    s_add_u32 s31, s31, 24576
    buffer_load_dwordx4 v4, s[16:19], s31 offen lds
AT_DV_51:
    v_add_f32 v229, v229, v231
    v_fma_f32 v6, v6, v227, v229
    s_cmp_eq_u64 s[36:37], 0
    s_cbranch_scc1 AT_RS_52
    v_mul_f32 v128, v227, v128
    v_mul_f32 v129, v227, v129
    v_mul_f32 v130, v227, v130
    v_mul_f32 v131, v227, v131
    v_mul_f32 v132, v227, v132
    v_mul_f32 v133, v227, v133
    v_mul_f32 v134, v227, v134
    v_mul_f32 v135, v227, v135
    v_mul_f32 v136, v227, v136
    v_mul_f32 v137, v227, v137
    v_mul_f32 v138, v227, v138
    v_mul_f32 v139, v227, v139
    v_mul_f32 v140, v227, v140
    v_mul_f32 v141, v227, v141
    v_mul_f32 v142, v227, v142
    v_mul_f32 v143, v227, v143
    v_mul_f32 v144, v227, v144
    v_mul_f32 v145, v227, v145
    v_mul_f32 v146, v227, v146
    v_mul_f32 v147, v227, v147
    v_mul_f32 v148, v227, v148
    v_mul_f32 v149, v227, v149
    v_mul_f32 v150, v227, v150
    v_mul_f32 v151, v227, v151
    v_mul_f32 v152, v227, v152
    v_mul_f32 v153, v227, v153
    v_mul_f32 v154, v227, v154
    v_mul_f32 v155, v227, v155
    v_mul_f32 v156, v227, v156
    v_mul_f32 v157, v227, v157
    v_mul_f32 v158, v227, v158
    v_mul_f32 v159, v227, v159
    v_mul_f32 v160, v227, v160
    v_mul_f32 v161, v227, v161
    v_mul_f32 v162, v227, v162
    v_mul_f32 v163, v227, v163
    v_mul_f32 v164, v227, v164
    v_mul_f32 v165, v227, v165
    v_mul_f32 v166, v227, v166
    v_mul_f32 v167, v227, v167
    v_mul_f32 v168, v227, v168
    v_mul_f32 v169, v227, v169
    v_mul_f32 v170, v227, v170
    v_mul_f32 v171, v227, v171
    v_mul_f32 v172, v227, v172
    v_mul_f32 v173, v227, v173
    v_mul_f32 v174, v227, v174
    v_mul_f32 v175, v227, v175
    v_mul_f32 v176, v227, v176
    v_mul_f32 v177, v227, v177
    v_mul_f32 v178, v227, v178
    v_mul_f32 v179, v227, v179
    v_mul_f32 v180, v227, v180
    v_mul_f32 v181, v227, v181
    v_mul_f32 v182, v227, v182
    v_mul_f32 v183, v227, v183
    v_mul_f32 v184, v227, v184
    v_mul_f32 v185, v227, v185
    v_mul_f32 v186, v227, v186
    v_mul_f32 v187, v227, v187
    v_mul_f32 v188, v227, v188
    v_mul_f32 v189, v227, v189
    v_mul_f32 v190, v227, v190
    v_mul_f32 v191, v227, v191
AT_RS_52:
    s_waitcnt lgkmcnt(4)
    v_mfma_f32_32x32x16_bf16 v[128:143], v[208:211], v[24:27], v[128:143]
    ds_read_b64_tr_b16 v[220:221], v3 offset:47360
    ds_read_b64_tr_b16 v[222:223], v3 offset:47488
    s_waitcnt lgkmcnt(4)
    v_mfma_f32_32x32x16_bf16 v[144:159], v[212:215], v[24:27], v[144:159]
    ds_read_b64_tr_b16 v[208:209], v3 offset:34560
    ds_read_b64_tr_b16 v[210:211], v3 offset:34688
    s_waitcnt lgkmcnt(4)
    v_mfma_f32_32x32x16_bf16 v[160:175], v[216:219], v[24:27], v[160:175]
    ds_read_b64_tr_b16 v[212:213], v3 offset:38912
    ds_read_b64_tr_b16 v[214:215], v3 offset:39040
    s_waitcnt lgkmcnt(4)
    v_mfma_f32_32x32x16_bf16 v[176:191], v[220:223], v[24:27], v[176:191]
    ds_read_b64_tr_b16 v[216:217], v3 offset:43264
    ds_read_b64_tr_b16 v[218:219], v3 offset:43392
    s_waitcnt lgkmcnt(4)
    v_mfma_f32_32x32x16_bf16 v[128:143], v[208:211], v[28:31], v[128:143]
    ds_read_b64_tr_b16 v[220:221], v3 offset:47616
    ds_read_b64_tr_b16 v[222:223], v3 offset:47744
    s_waitcnt lgkmcnt(4)
    v_mfma_f32_32x32x16_bf16 v[144:159], v[212:215], v[28:31], v[144:159]
    s_waitcnt lgkmcnt(2)
    v_mfma_f32_32x32x16_bf16 v[160:175], v[216:219], v[28:31], v[160:175]
    s_waitcnt lgkmcnt(0)
    v_mfma_f32_32x32x16_bf16 v[176:191], v[220:223], v[28:31], v[176:191]
AT_TLN:
    v_mov_b32 v224, v6
    s_nop 1
    v_permlane32_swap_b32 v6, v224
    v_add_f32 v6, v6, v224
    s_barrier
    s_mul_i32 s31, s27, 33792
    s_lshr_b32 s32, s5, 1
    s_mul_i32 s32, s32, 67584
    s_add_u32 s31, s31, s32
    s_and_b32 s32, s5, 1
    s_lshl_b32 s32, s32, 14
    s_add_u32 s31, s31, s32
    v_lshlrev_b32 v224, 4, v1
    v_add_u32 v224, s31, v224
    s_lshl_b32 s32, s5, 9
    s_add_u32 s32, s32, 135168
    v_lshlrev_b32 v225, 3, v1
    v_add_u32 v225, s32, v225
    s_cmp_eq_u32 s4, 0
    s_cbranch_scc1 AT_MERGE_WAIT
    ds_write_b128 v224, v[128:131] offset:0
    ds_write_b128 v224, v[132:135] offset:1024
    ds_write_b128 v224, v[136:139] offset:2048
    ds_write_b128 v224, v[140:143] offset:3072
    ds_write_b128 v224, v[144:147] offset:4096
    ds_write_b128 v224, v[148:151] offset:5120
    ds_write_b128 v224, v[152:155] offset:6144
    ds_write_b128 v224, v[156:159] offset:7168
    ds_write_b128 v224, v[160:163] offset:8192
    ds_write_b128 v224, v[164:167] offset:9216
    ds_write_b128 v224, v[168:171] offset:10240
    ds_write_b128 v224, v[172:175] offset:11264
    ds_write_b128 v224, v[176:179] offset:12288
    ds_write_b128 v224, v[180:183] offset:13312
    ds_write_b128 v224, v[184:187] offset:14336
    ds_write_b128 v224, v[188:191] offset:15360
    v_mov_b32 v248, v5
    v_mov_b32 v249, v6
    ds_write_b64 v225, v[248:249]
    s_waitcnt lgkmcnt(0)
AT_MERGE_WAIT:
    s_barrier
    s_cmp_eq_u32 s4, 0
    s_cbranch_scc0 AT_MERGE_DONE
    ds_read_b128 v[64:67], v224 offset:0
    ds_read_b128 v[68:71], v224 offset:1024
    ds_read_b128 v[72:75], v224 offset:2048
    ds_read_b128 v[76:79], v224 offset:3072
    ds_read_b128 v[80:83], v224 offset:4096
    ds_read_b128 v[84:87], v224 offset:5120
    ds_read_b128 v[88:91], v224 offset:6144
    ds_read_b128 v[92:95], v224 offset:7168
    ds_read_b128 v[96:99], v224 offset:8192
    ds_read_b128 v[100:103], v224 offset:9216
    ds_read_b128 v[104:107], v224 offset:10240
    ds_read_b128 v[108:111], v224 offset:11264
    ds_read_b128 v[112:115], v224 offset:12288
    ds_read_b128 v[116:119], v224 offset:13312
    ds_read_b128 v[120:123], v224 offset:14336
    ds_read_b128 v[124:127], v224 offset:15360
    ds_read_b64 v[248:249], v225
    s_waitcnt lgkmcnt(0)
    v_max_f32 v228, v5, v248
    v_sub_f32 v229, v5, v228
    v_sub_f32 v230, v248, v228
    v_mul_f32 v229, s30, v229
    v_mul_f32 v230, s30, v230
    v_exp_f32 v229, v229
    v_exp_f32 v230, v230
    v_mul_f32 v231, v6, v229
    v_fma_f32 v231, v249, v230, v231
    v_rcp_f32 v231, v231
    s_nop 0
    v_mul_f32 v229, v229, v231
    v_mul_f32 v230, v230, v231
    v_mul_f32 v128, v128, v229
    v_mul_f32 v129, v129, v229
    v_mul_f32 v130, v130, v229
    v_mul_f32 v131, v131, v229
    v_mul_f32 v132, v132, v229
    v_mul_f32 v133, v133, v229
    v_mul_f32 v134, v134, v229
    v_mul_f32 v135, v135, v229
    v_mul_f32 v136, v136, v229
    v_mul_f32 v137, v137, v229
    v_mul_f32 v138, v138, v229
    v_mul_f32 v139, v139, v229
    v_mul_f32 v140, v140, v229
    v_mul_f32 v141, v141, v229
    v_mul_f32 v142, v142, v229
    v_mul_f32 v143, v143, v229
    v_mul_f32 v144, v144, v229
    v_mul_f32 v145, v145, v229
    v_mul_f32 v146, v146, v229
    v_mul_f32 v147, v147, v229
    v_mul_f32 v148, v148, v229
    v_mul_f32 v149, v149, v229
    v_mul_f32 v150, v150, v229
    v_mul_f32 v151, v151, v229
    v_mul_f32 v152, v152, v229
    v_mul_f32 v153, v153, v229
    v_mul_f32 v154, v154, v229
    v_mul_f32 v155, v155, v229
    v_mul_f32 v156, v156, v229
    v_mul_f32 v157, v157, v229
    v_mul_f32 v158, v158, v229
    v_mul_f32 v159, v159, v229
    v_mul_f32 v160, v160, v229
    v_mul_f32 v161, v161, v229
    v_mul_f32 v162, v162, v229
    v_mul_f32 v163, v163, v229
    v_mul_f32 v164, v164, v229
    v_mul_f32 v165, v165, v229
    v_mul_f32 v166, v166, v229
    v_mul_f32 v167, v167, v229
    v_mul_f32 v168, v168, v229
    v_mul_f32 v169, v169, v229
    v_mul_f32 v170, v170, v229
    v_mul_f32 v171, v171, v229
    v_mul_f32 v172, v172, v229
    v_mul_f32 v173, v173, v229
    v_mul_f32 v174, v174, v229
    v_mul_f32 v175, v175, v229
    v_mul_f32 v176, v176, v229
    v_mul_f32 v177, v177, v229
    v_mul_f32 v178, v178, v229
    v_mul_f32 v179, v179, v229
    v_mul_f32 v180, v180, v229
    v_mul_f32 v181, v181, v229
    v_mul_f32 v182, v182, v229
    v_mul_f32 v183, v183, v229
    v_mul_f32 v184, v184, v229
    v_mul_f32 v185, v185, v229
    v_mul_f32 v186, v186, v229
    v_mul_f32 v187, v187, v229
    v_mul_f32 v188, v188, v229
    v_mul_f32 v189, v189, v229
    v_mul_f32 v190, v190, v229
    v_mul_f32 v191, v191, v229
    v_fma_f32 v128, v64, v230, v128
    v_fma_f32 v129, v65, v230, v129
    v_fma_f32 v130, v66, v230, v130
    v_fma_f32 v131, v67, v230, v131
    v_fma_f32 v132, v68, v230, v132
    v_fma_f32 v133, v69, v230, v133
    v_fma_f32 v134, v70, v230, v134
    v_fma_f32 v135, v71, v230, v135
    v_fma_f32 v136, v72, v230, v136
    v_fma_f32 v137, v73, v230, v137
    v_fma_f32 v138, v74, v230, v138
    v_fma_f32 v139, v75, v230, v139
    v_fma_f32 v140, v76, v230, v140
    v_fma_f32 v141, v77, v230, v141
    v_fma_f32 v142, v78, v230, v142
    v_fma_f32 v143, v79, v230, v143
    v_fma_f32 v144, v80, v230, v144
    v_fma_f32 v145, v81, v230, v145
    v_fma_f32 v146, v82, v230, v146
    v_fma_f32 v147, v83, v230, v147
    v_fma_f32 v148, v84, v230, v148
    v_fma_f32 v149, v85, v230, v149
    v_fma_f32 v150, v86, v230, v150
    v_fma_f32 v151, v87, v230, v151
    v_fma_f32 v152, v88, v230, v152
    v_fma_f32 v153, v89, v230, v153
    v_fma_f32 v154, v90, v230, v154
    v_fma_f32 v155, v91, v230, v155
    v_fma_f32 v156, v92, v230, v156
    v_fma_f32 v157, v93, v230, v157
    v_fma_f32 v158, v94, v230, v158
    v_fma_f32 v159, v95, v230, v159
    v_fma_f32 v160, v96, v230, v160
    v_fma_f32 v161, v97, v230, v161
    v_fma_f32 v162, v98, v230, v162
    v_fma_f32 v163, v99, v230, v163
    v_fma_f32 v164, v100, v230, v164
    v_fma_f32 v165, v101, v230, v165
    v_fma_f32 v166, v102, v230, v166
    v_fma_f32 v167, v103, v230, v167
    v_fma_f32 v168, v104, v230, v168
    v_fma_f32 v169, v105, v230, v169
    v_fma_f32 v170, v106, v230, v170
    v_fma_f32 v171, v107, v230, v171
    v_fma_f32 v172, v108, v230, v172
    v_fma_f32 v173, v109, v230, v173
    v_fma_f32 v174, v110, v230, v174
    v_fma_f32 v175, v111, v230, v175
    v_fma_f32 v176, v112, v230, v176
    v_fma_f32 v177, v113, v230, v177
    v_fma_f32 v178, v114, v230, v178
    v_fma_f32 v179, v115, v230, v179
    v_fma_f32 v180, v116, v230, v180
    v_fma_f32 v181, v117, v230, v181
    v_fma_f32 v182, v118, v230, v182
    v_fma_f32 v183, v119, v230, v183
    v_fma_f32 v184, v120, v230, v184
    v_fma_f32 v185, v121, v230, v185
    v_fma_f32 v186, v122, v230, v186
    v_fma_f32 v187, v123, v230, v187
    v_fma_f32 v188, v124, v230, v188
    v_fma_f32 v189, v125, v230, v189
    v_fma_f32 v190, v126, v230, v190
    v_fma_f32 v191, v127, v230, v191
    s_mul_i32 s32, s24, 1441792
    s_lshl_b32 s33, s6, 15
    s_add_u32 s32, s32, s33
    v_cvt_pk_bf16_f32 v192, v128, v129
    v_cvt_pk_bf16_f32 v193, v130, v131
    v_cvt_pk_bf16_f32 v194, v132, v133
    v_cvt_pk_bf16_f32 v195, v134, v135
    s_nop 0
    v_permlane32_swap_b32 v192, v194
    v_permlane32_swap_b32 v193, v195
    s_add_u32 s33, s32, 0
    buffer_store_dwordx4 v[192:195], v9, s[20:23], s33 offen
    v_cvt_pk_bf16_f32 v196, v136, v137
    v_cvt_pk_bf16_f32 v197, v138, v139
    v_cvt_pk_bf16_f32 v198, v140, v141
    v_cvt_pk_bf16_f32 v199, v142, v143
    s_nop 0
    v_permlane32_swap_b32 v196, v198
    v_permlane32_swap_b32 v197, v199
    s_add_u32 s33, s32, 4096
    buffer_store_dwordx4 v[196:199], v9, s[20:23], s33 offen
    v_cvt_pk_bf16_f32 v200, v144, v145
    v_cvt_pk_bf16_f32 v201, v146, v147
    v_cvt_pk_bf16_f32 v202, v148, v149
    v_cvt_pk_bf16_f32 v203, v150, v151
    s_nop 0
    v_permlane32_swap_b32 v200, v202
    v_permlane32_swap_b32 v201, v203
    s_add_u32 s33, s32, 8192
    buffer_store_dwordx4 v[200:203], v9, s[20:23], s33 offen
    v_cvt_pk_bf16_f32 v204, v152, v153
    v_cvt_pk_bf16_f32 v205, v154, v155
    v_cvt_pk_bf16_f32 v206, v156, v157
    v_cvt_pk_bf16_f32 v207, v158, v159
    s_nop 0
    v_permlane32_swap_b32 v204, v206
    v_permlane32_swap_b32 v205, v207
    s_add_u32 s33, s32, 12288
    buffer_store_dwordx4 v[204:207], v9, s[20:23], s33 offen
    v_cvt_pk_bf16_f32 v192, v160, v161
    v_cvt_pk_bf16_f32 v193, v162, v163
    v_cvt_pk_bf16_f32 v194, v164, v165
    v_cvt_pk_bf16_f32 v195, v166, v167
    s_nop 0
    v_permlane32_swap_b32 v192, v194
    v_permlane32_swap_b32 v193, v195
    s_add_u32 s33, s32, 16384
    buffer_store_dwordx4 v[192:195], v9, s[20:23], s33 offen
    v_cvt_pk_bf16_f32 v196, v168, v169
    v_cvt_pk_bf16_f32 v197, v170, v171
    v_cvt_pk_bf16_f32 v198, v172, v173
    v_cvt_pk_bf16_f32 v199, v174, v175
    s_nop 0
    v_permlane32_swap_b32 v196, v198
    v_permlane32_swap_b32 v197, v199
    s_add_u32 s33, s32, 20480
    buffer_store_dwordx4 v[196:199], v9, s[20:23], s33 offen
    v_cvt_pk_bf16_f32 v200, v176, v177
    v_cvt_pk_bf16_f32 v201, v178, v179
    v_cvt_pk_bf16_f32 v202, v180, v181
    v_cvt_pk_bf16_f32 v203, v182, v183
    s_nop 0
    v_permlane32_swap_b32 v200, v202
    v_permlane32_swap_b32 v201, v203
    s_add_u32 s33, s32, 24576
    buffer_store_dwordx4 v[200:203], v9, s[20:23], s33 offen
    v_cvt_pk_bf16_f32 v204, v184, v185
    v_cvt_pk_bf16_f32 v205, v186, v187
    v_cvt_pk_bf16_f32 v206, v188, v189
    v_cvt_pk_bf16_f32 v207, v190, v191
    s_nop 0
    v_permlane32_swap_b32 v204, v206
    v_permlane32_swap_b32 v205, v207
    s_add_u32 s33, s32, 28672
    buffer_store_dwordx4 v[204:207], v9, s[20:23], s33 offen
AT_MERGE_DONE:
    s_xor_b32 s27, s27, 1
    s_add_u32 s26, s26, 1
    s_cmp_lt_u32 s26, 2
    s_cbranch_scc1 AT_QBLOCK
AT_EXIT:
    s_endpgm
.globl gemmc_kernel
.p2align 8
.type gemmc_kernel,@function
gemmc_kernel:
    s_cmp_ge_u32 s2, 256
    s_cbranch_scc1 GC_EXIT
    s_and_b32 s36, s2, 7
    s_lshr_b32 s37, s2, 3
    s_lshl_b32 s43, s36, 1
    s_and_b32 s36, s37, 1
    s_add_u32 s43, s43, s36
    s_lshr_b32 s44, s37, 1
    s_and_b32 s44, s44, 3
    s_lshr_b32 s42, s37, 3
    s_load_dwordx2 s[50:51], s[0:1], 40
    s_load_dwordx2 s[52:53], s[0:1], 72
    s_load_dwordx2 s[54:55], s[0:1], 104
    v_lshrrev_b32 v1, 6, v0
    s_nop 0
    v_readfirstlane_b32 s3, v1
    s_nop 3
    s_lshr_b32 s47, s3, 1
    s_and_b32 s48, s3, 1
    s_waitcnt lgkmcnt(0)
    s_mov_b32 s40, 1024
    s_add_u32 s56, s54, 54525952
    s_addc_u32 s57, s55, 0
    s_mov_b32 s8, s56
    s_mov_b32 s9, s57
    s_mov_b32 s10, 23068672
    s_mov_b32 s11, 0x00020000
    s_add_u32 s56, s54, 83886080
    s_addc_u32 s57, s55, 0
    s_mov_b32 s16, s56
    s_mov_b32 s17, s57
    s_mov_b32 s18, 16777216
    s_mov_b32 s19, 0x00020000
    s_mul_i32 s49, s42, 43
    s_mov_b32 s31, 43
    s_cmp_eq_u32 s42, 3
    s_cselect_b32 s31, 42, s31
    s_cmp_ge_u32 s49, 128
    s_cbranch_scc1 GC_W2
    s_mov_b32 s12, s50
    s_mov_b32 s13, s51
    s_mov_b32 s14, 4194304
    s_mov_b32 s15, 0x00020000
    s_mov_b32 s37, s49
    s_branch GC_WSET
GC_W2:
    s_mov_b32 s12, s52
    s_mov_b32 s13, s53
    s_mov_b32 s14, 1409024
    s_mov_b32 s15, 0x00020000
    s_sub_u32 s37, s49, 128
GC_WSET:
    s_lshl_b32 s37, s37, 15
    s_lshl_b32 s36, s44, 8
    s_add_u32 s37, s37, s36
    s_add_u32 s36, s3, 0
    s_mul_i32 s36, s36, 4096
    s_add_u32 s24, s36, s37
    s_add_u32 s36, s3, 4
    s_mul_i32 s36, s36, 4096
    s_add_u32 s25, s36, s37
    s_mov_b32 s34, 32768
    s_mul_i32 s36, s43, 1441792
    s_lshl_b32 s37, s3, 11
    s_add_u32 s36, s36, s37
    s_lshl_b32 s37, s49, 13
    s_add_u32 s36, s36, s37
    s_add_u32 s28, s36, 0
    s_mul_i32 s36, s43, 1441792
    s_lshl_b32 s37, s3, 11
    s_add_u32 s36, s36, s37
    s_lshl_b32 s37, s49, 13
    s_add_u32 s36, s36, s37
    s_add_u32 s29, s36, 1024
    v_and_b32 v1, 63, v0
    v_lshrrev_b32 v10, 5, v1
    v_and_b32 v11, 15, v1
    v_lshrrev_b32 v12, 2, v11
    v_and_b32 v13, 3, v11
    v_bfe_u32 v14, v1, 4, 1
    v_lshl_add_u32 v15, v10, 3, v12
    v_mul_u32_u24 v15, 256, v15
    v_lshlrev_b32 v14, 5, v14
    v_lshl_add_u32 v14, v13, 3, v14
    v_add_u32 v15, v15, v14
    s_mul_i32 s36, s47, 2
    s_add_u32 s37, s36, 0
    v_xor_b32 v2, s37, v12
    v_lshl_add_u32 v2, v2, 6, v15
    s_add_u32 s37, s36, 1
    v_xor_b32 v3, s37, v12
    v_lshl_add_u32 v3, v3, 6, v15
    v_and_b32 v12, 31, v1
    s_lshl_b32 s36, s48, 6
    v_add_u32 v12, s36, v12
    v_lshlrev_b32 v12, 4, v12
    v_lshl_add_u32 v12, v10, 11, v12
    v_add_u32 v6, 8192, v12
    v_lshrrev_b32 v10, 4, v1
    v_and_b32 v11, 15, v1
    v_lshrrev_b32 v12, 2, v11
    v_mov_b32 v13, v10
    v_xor_b32 v12, v12, v13
    v_and_b32 v11, 3, v11
    v_lshlrev_b32 v11, 4, v11
    v_lshl_add_u32 v11, v12, 6, v11
    v_mul_lo_u32 v10, v10, s40
    v_add_u32 v8, v10, v11
    v_lshlrev_b32 v9, 4, v1
    s_mov_b32 s32, 0
    s_mov_b32 s33, 32768
    s_add_u32 s33, s33, 16384
    s_cmp_eq_u32 s33, 49152
    s_cselect_b32 s33, 0, s33
    s_lshl_b32 s36, s3, 10
    s_add_u32 s38, s33, s36
    s_lshl_b32 s36, s3, 11
    s_add_u32 s39, s33, s36
    s_add_u32 s39, s39, 8192
    s_add_u32 m0, s38, 0
    s_nop 0
    buffer_load_dwordx4 v8, s[12:15], s24 offen lds
    s_add_u32 s24, s24, s34
    s_add_u32 m0, s38, 4096
    s_nop 0
    buffer_load_dwordx4 v8, s[12:15], s25 offen lds
    s_add_u32 s25, s25, s34
    s_add_u32 m0, s39, 0
    s_nop 0
    buffer_load_dwordx4 v9, s[8:11], s28 offen lds
    s_add_u32 s28, s28, 8192
    s_add_u32 m0, s39, 1024
    s_nop 0
    buffer_load_dwordx4 v9, s[8:11], s29 offen lds
    s_add_u32 s29, s29, 8192
    s_add_u32 s33, s33, 16384
    s_cmp_eq_u32 s33, 49152
    s_cselect_b32 s33, 0, s33
    s_lshl_b32 s36, s3, 10
    s_add_u32 s38, s33, s36
    s_lshl_b32 s36, s3, 11
    s_add_u32 s39, s33, s36
    s_add_u32 s39, s39, 8192
    s_add_u32 s49, s49, 1
    s_cmp_eq_u32 s49, 128
    s_cbranch_scc0 GC_NOSW_1
    s_mov_b32 s12, s52
    s_mov_b32 s13, s53
    s_mov_b32 s14, 1409024
    s_mov_b32 s15, 0x00020000
    s_sub_u32 s24, s24, 4194304
    s_sub_u32 s25, s25, 4194304
GC_NOSW_1:
    s_add_u32 m0, s38, 0
    s_nop 0
    buffer_load_dwordx4 v8, s[12:15], s24 offen lds
    s_add_u32 s24, s24, s34
    s_add_u32 m0, s38, 4096
    s_nop 0
    buffer_load_dwordx4 v8, s[12:15], s25 offen lds
    s_add_u32 s25, s25, s34
    s_add_u32 m0, s39, 0
    s_nop 0
    buffer_load_dwordx4 v9, s[8:11], s28 offen lds
    s_add_u32 s28, s28, 8192
    s_add_u32 m0, s39, 1024
    s_nop 0
    buffer_load_dwordx4 v9, s[8:11], s29 offen lds
    s_add_u32 s29, s29, 8192
    s_add_u32 s33, s33, 16384
    s_cmp_eq_u32 s33, 49152
    s_cselect_b32 s33, 0, s33
    s_lshl_b32 s36, s3, 10
    s_add_u32 s38, s33, s36
    s_lshl_b32 s36, s3, 11
    s_add_u32 s39, s33, s36
    s_add_u32 s39, s39, 8192
    s_add_u32 s49, s49, 1
    s_cmp_eq_u32 s49, 128
    s_cbranch_scc0 GC_NOSW_2
    s_mov_b32 s12, s52
    s_mov_b32 s13, s53
    s_mov_b32 s14, 1409024
    s_mov_b32 s15, 0x00020000
    s_sub_u32 s24, s24, 4194304
    s_sub_u32 s25, s25, 4194304
GC_NOSW_2:
    v_mov_b32 v64, 0
    v_mov_b32 v65, 0
    v_mov_b32 v66, 0
    v_mov_b32 v67, 0
    v_mov_b32 v68, 0
    v_mov_b32 v69, 0
    v_mov_b32 v70, 0
    v_mov_b32 v71, 0
    v_mov_b32 v72, 0
    v_mov_b32 v73, 0
    v_mov_b32 v74, 0
    v_mov_b32 v75, 0
    v_mov_b32 v76, 0
    v_mov_b32 v77, 0
    v_mov_b32 v78, 0
    v_mov_b32 v79, 0
    v_mov_b32 v80, 0
    v_mov_b32 v81, 0
    v_mov_b32 v82, 0
    v_mov_b32 v83, 0
    v_mov_b32 v84, 0
    v_mov_b32 v85, 0
    v_mov_b32 v86, 0
    v_mov_b32 v87, 0
    v_mov_b32 v88, 0
    v_mov_b32 v89, 0
    v_mov_b32 v90, 0
    v_mov_b32 v91, 0
    v_mov_b32 v92, 0
    v_mov_b32 v93, 0
    v_mov_b32 v94, 0
    v_mov_b32 v95, 0
    v_mov_b32 v96, 0
    v_mov_b32 v97, 0
    v_mov_b32 v98, 0
    v_mov_b32 v99, 0
    v_mov_b32 v100, 0
    v_mov_b32 v101, 0
    v_mov_b32 v102, 0
    v_mov_b32 v103, 0
    v_mov_b32 v104, 0
    v_mov_b32 v105, 0
    v_mov_b32 v106, 0
    v_mov_b32 v107, 0
    v_mov_b32 v108, 0
    v_mov_b32 v109, 0
    v_mov_b32 v110, 0
    v_mov_b32 v111, 0
    v_mov_b32 v112, 0
    v_mov_b32 v113, 0
    v_mov_b32 v114, 0
    v_mov_b32 v115, 0
    v_mov_b32 v116, 0
    v_mov_b32 v117, 0
    v_mov_b32 v118, 0
    v_mov_b32 v119, 0
    v_mov_b32 v120, 0
    v_mov_b32 v121, 0
    v_mov_b32 v122, 0
    v_mov_b32 v123, 0
    v_mov_b32 v124, 0
    v_mov_b32 v125, 0
    v_mov_b32 v126, 0
    v_mov_b32 v127, 0
    s_mov_b32 s30, 0
    s_sub_u32 s31, s31, 2
L_gc_loop:
    s_waitcnt vmcnt(4)
    s_barrier
    ds_read_b64_tr_b16 v[16:17], v2 offset:0
    ds_read_b64_tr_b16 v[18:19], v2 offset:1024
    ds_read_b128 v[32:35], v6 offset:0
    ds_read_b128 v[36:39], v6 offset:512
    ds_read_b64_tr_b16 v[20:21], v3 offset:0
    ds_read_b64_tr_b16 v[22:23], v3 offset:1024
    ds_read_b64_tr_b16 v[24:25], v2 offset:4096
    ds_read_b64_tr_b16 v[26:27], v2 offset:5120
    ds_read_b128 v[40:43], v6 offset:4096
    ds_read_b128 v[44:47], v6 offset:4608
    ds_read_b64_tr_b16 v[28:29], v3 offset:4096
    ds_read_b64_tr_b16 v[30:31], v3 offset:5120
    s_add_u32 s36, s32, 16384
    s_cmp_eq_u32 s36, 49152
    s_cselect_b32 s36, 0, s36
    s_sub_u32 s35, s36, s32
    s_mov_b32 s32, s36
    v_add_u32 v2, s35, v2
    v_add_u32 v3, s35, v3
    v_add_u32 v6, s35, v6
    s_waitcnt lgkmcnt(9)
    v_mfma_f32_32x32x16_bf16 v[64:79], v[16:19], v[32:35], v[64:79]
    s_add_u32 m0, s38, 0
    s_nop 0
    buffer_load_dwordx4 v8, s[12:15], s24 offen lds
    s_add_u32 s24, s24, s34
    s_waitcnt lgkmcnt(8)
    v_mfma_f32_32x32x16_bf16 v[80:95], v[16:19], v[36:39], v[80:95]
    s_waitcnt lgkmcnt(6)
    v_mfma_f32_32x32x16_bf16 v[96:111], v[20:23], v[32:35], v[96:111]
    s_add_u32 m0, s38, 4096
    s_nop 0
    buffer_load_dwordx4 v8, s[12:15], s25 offen lds
    s_add_u32 s25, s25, s34
    v_mfma_f32_32x32x16_bf16 v[112:127], v[20:23], v[36:39], v[112:127]
    s_waitcnt lgkmcnt(3)
    v_mfma_f32_32x32x16_bf16 v[64:79], v[24:27], v[40:43], v[64:79]
    s_add_u32 m0, s39, 0
    s_nop 0
    buffer_load_dwordx4 v9, s[8:11], s28 offen lds
    s_add_u32 s28, s28, 8192
    s_waitcnt lgkmcnt(2)
    v_mfma_f32_32x32x16_bf16 v[80:95], v[24:27], v[44:47], v[80:95]
    s_waitcnt lgkmcnt(0)
    v_mfma_f32_32x32x16_bf16 v[96:111], v[28:31], v[40:43], v[96:111]
    s_add_u32 m0, s39, 1024
    s_nop 0
    buffer_load_dwordx4 v9, s[8:11], s29 offen lds
    s_add_u32 s29, s29, 8192
    v_mfma_f32_32x32x16_bf16 v[112:127], v[28:31], v[44:47], v[112:127]
    s_add_u32 s33, s33, 16384
    s_cmp_eq_u32 s33, 49152
    s_cselect_b32 s33, 0, s33
    s_lshl_b32 s36, s3, 10
    s_add_u32 s38, s33, s36
    s_lshl_b32 s36, s3, 11
    s_add_u32 s39, s33, s36
    s_add_u32 s39, s39, 8192
    s_add_u32 s49, s49, 1
    s_cmp_eq_u32 s49, 128
    s_cbranch_scc0 GC_NOSW_3
    s_mov_b32 s12, s52
    s_mov_b32 s13, s53
    s_mov_b32 s14, 1409024
    s_mov_b32 s15, 0x00020000
    s_sub_u32 s24, s24, 4194304
    s_sub_u32 s25, s25, 4194304
GC_NOSW_3:
    s_add_u32 s30, s30, 1
    s_cmp_lt_u32 s30, s31
    s_cbranch_scc1 L_gc_loop
    s_waitcnt vmcnt(4)
    s_barrier
    ds_read_b64_tr_b16 v[16:17], v2 offset:0
    ds_read_b64_tr_b16 v[18:19], v2 offset:1024
    ds_read_b128 v[32:35], v6 offset:0
    ds_read_b128 v[36:39], v6 offset:512
    ds_read_b64_tr_b16 v[20:21], v3 offset:0
    ds_read_b64_tr_b16 v[22:23], v3 offset:1024
    ds_read_b64_tr_b16 v[24:25], v2 offset:4096
    ds_read_b64_tr_b16 v[26:27], v2 offset:5120
    ds_read_b128 v[40:43], v6 offset:4096
    ds_read_b128 v[44:47], v6 offset:4608
    ds_read_b64_tr_b16 v[28:29], v3 offset:4096
    ds_read_b64_tr_b16 v[30:31], v3 offset:5120
    s_add_u32 s36, s32, 16384
    s_cmp_eq_u32 s36, 49152
    s_cselect_b32 s36, 0, s36
    s_sub_u32 s35, s36, s32
    s_mov_b32 s32, s36
    v_add_u32 v2, s35, v2
    v_add_u32 v3, s35, v3
    v_add_u32 v6, s35, v6
    s_waitcnt lgkmcnt(9)
    v_mfma_f32_32x32x16_bf16 v[64:79], v[16:19], v[32:35], v[64:79]
    s_waitcnt lgkmcnt(8)
    v_mfma_f32_32x32x16_bf16 v[80:95], v[16:19], v[36:39], v[80:95]
    s_waitcnt lgkmcnt(6)
    v_mfma_f32_32x32x16_bf16 v[96:111], v[20:23], v[32:35], v[96:111]
    v_mfma_f32_32x32x16_bf16 v[112:127], v[20:23], v[36:39], v[112:127]
    s_waitcnt lgkmcnt(3)
    v_mfma_f32_32x32x16_bf16 v[64:79], v[24:27], v[40:43], v[64:79]
    s_waitcnt lgkmcnt(2)
    v_mfma_f32_32x32x16_bf16 v[80:95], v[24:27], v[44:47], v[80:95]
    s_waitcnt lgkmcnt(0)
    v_mfma_f32_32x32x16_bf16 v[96:111], v[28:31], v[40:43], v[96:111]
    v_mfma_f32_32x32x16_bf16 v[112:127], v[28:31], v[44:47], v[112:127]
    s_waitcnt vmcnt(0)
    s_barrier
    ds_read_b64_tr_b16 v[16:17], v2 offset:0
    ds_read_b64_tr_b16 v[18:19], v2 offset:1024
    ds_read_b128 v[32:35], v6 offset:0
    ds_read_b128 v[36:39], v6 offset:512
    ds_read_b64_tr_b16 v[20:21], v3 offset:0
    ds_read_b64_tr_b16 v[22:23], v3 offset:1024
    ds_read_b64_tr_b16 v[24:25], v2 offset:4096
    ds_read_b64_tr_b16 v[26:27], v2 offset:5120
    ds_read_b128 v[40:43], v6 offset:4096
    ds_read_b128 v[44:47], v6 offset:4608
    ds_read_b64_tr_b16 v[28:29], v3 offset:4096
    ds_read_b64_tr_b16 v[30:31], v3 offset:5120
    s_add_u32 s36, s32, 16384
    s_cmp_eq_u32 s36, 49152
    s_cselect_b32 s36, 0, s36
    s_sub_u32 s35, s36, s32
    s_mov_b32 s32, s36
    v_add_u32 v2, s35, v2
    v_add_u32 v3, s35, v3
    v_add_u32 v6, s35, v6
    s_waitcnt lgkmcnt(9)
    v_mfma_f32_32x32x16_bf16 v[64:79], v[16:19], v[32:35], v[64:79]
    s_waitcnt lgkmcnt(8)
    v_mfma_f32_32x32x16_bf16 v[80:95], v[16:19], v[36:39], v[80:95]
    s_waitcnt lgkmcnt(6)
    v_mfma_f32_32x32x16_bf16 v[96:111], v[20:23], v[32:35], v[96:111]
    v_mfma_f32_32x32x16_bf16 v[112:127], v[20:23], v[36:39], v[112:127]
    s_waitcnt lgkmcnt(3)
    v_mfma_f32_32x32x16_bf16 v[64:79], v[24:27], v[40:43], v[64:79]
    s_waitcnt lgkmcnt(2)
    v_mfma_f32_32x32x16_bf16 v[80:95], v[24:27], v[44:47], v[80:95]
    s_waitcnt lgkmcnt(0)
    v_mfma_f32_32x32x16_bf16 v[96:111], v[28:31], v[40:43], v[96:111]
    v_mfma_f32_32x32x16_bf16 v[112:127], v[28:31], v[44:47], v[112:127]
    s_waitcnt vmcnt(0)
    s_nop 15
    s_nop 7
    s_lshl_b32 s36, s42, 22
    s_lshl_b32 s37, s43, 2
    s_add_u32 s37, s37, s44
    s_lshl_b32 s37, s37, 16
    s_add_u32 s36, s36, s37
    s_lshl_b32 s37, s3, 14
    s_add_u32 s36, s36, s37
    v_lshlrev_b32 v10, 4, v1
    buffer_store_dwordx4 v[64:67], v10, s[16:19], s36 offen offset:0
    buffer_store_dwordx4 v[68:71], v10, s[16:19], s36 offen offset:1024
    buffer_store_dwordx4 v[72:75], v10, s[16:19], s36 offen offset:2048
    buffer_store_dwordx4 v[76:79], v10, s[16:19], s36 offen offset:3072
    s_add_u32 s36, s36, 4096
    buffer_store_dwordx4 v[80:83], v10, s[16:19], s36 offen offset:0
    buffer_store_dwordx4 v[84:87], v10, s[16:19], s36 offen offset:1024
    buffer_store_dwordx4 v[88:91], v10, s[16:19], s36 offen offset:2048
    buffer_store_dwordx4 v[92:95], v10, s[16:19], s36 offen offset:3072
    s_add_u32 s36, s36, 4096
    buffer_store_dwordx4 v[96:99], v10, s[16:19], s36 offen offset:0
    buffer_store_dwordx4 v[100:103], v10, s[16:19], s36 offen offset:1024
    buffer_store_dwordx4 v[104:107], v10, s[16:19], s36 offen offset:2048
    buffer_store_dwordx4 v[108:111], v10, s[16:19], s36 offen offset:3072
    s_add_u32 s36, s36, 4096
    buffer_store_dwordx4 v[112:115], v10, s[16:19], s36 offen offset:0
    buffer_store_dwordx4 v[116:119], v10, s[16:19], s36 offen offset:1024
    buffer_store_dwordx4 v[120:123], v10, s[16:19], s36 offen offset:2048
    buffer_store_dwordx4 v[124:127], v10, s[16:19], s36 offen offset:3072
    s_add_u32 s36, s36, 4096
GC_EXIT:
    s_endpgm
.globl reduce_kernel
.p2align 8
.type reduce_kernel,@function
reduce_kernel:
    s_cmp_ge_u32 s2, 1024
    s_cbranch_scc1 RD_EXIT
    s_load_dwordx2 s[4:5], s[0:1], 0
    s_load_dwordx2 s[6:7], s[0:1], 80
    s_load_dwordx2 s[24:25], s[0:1], 88
    s_load_dwordx2 s[26:27], s[0:1], 104
    s_lshl_b32 s3, s2, 8
    v_add_u32 v1, s3, v0
    v_lshlrev_b32 v2, 4, v1
    v_and_b32 v3, 63, v1
    v_bfe_u32 v4, v1, 6, 2
    v_bfe_u32 v5, v1, 8, 2
    v_bfe_u32 v6, v1, 10, 2
    v_lshrrev_b32 v7, 12, v1
    v_lshrrev_b32 v8, 2, v7
    v_lshlrev_b32 v8, 7, v8
    v_and_b32 v9, 1, v6
    v_lshl_add_u32 v8, v9, 6, v8
    v_and_b32 v9, 1, v5
    v_lshl_add_u32 v8, v9, 5, v8
    v_and_b32 v9, 31, v3
    v_add_u32 v8, v8, v9
    v_and_b32 v9, 3, v7
    v_lshlrev_b32 v9, 7, v9
    v_lshrrev_b32 v10, 1, v6
    v_lshl_add_u32 v9, v10, 6, v9
    v_lshrrev_b32 v10, 1, v5
    v_lshl_add_u32 v9, v10, 5, v9
    v_lshl_add_u32 v9, v4, 3, v9
    v_lshrrev_b32 v10, 5, v3
    v_lshl_add_u32 v9, v10, 2, v9
    v_lshl_add_u32 v10, v8, 9, v9
    v_lshlrev_b32 v10, 1, v10
    v_lshlrev_b32 v11, 1, v9
    s_waitcnt lgkmcnt(0)
    s_mov_b32 s8, s4
    s_mov_b32 s9, s5
    s_mov_b32 s10, 2097152
    s_mov_b32 s11, 0x00020000
    s_mov_b32 s12, s6
    s_mov_b32 s13, s7
    s_mov_b32 s14, 1024
    s_mov_b32 s15, 0x00020000
    s_mov_b32 s16, s24
    s_mov_b32 s17, s25
    s_mov_b32 s18, 2097152
    s_mov_b32 s19, 0x00020000
    s_add_u32 s26, s26, 83886080
    s_addc_u32 s27, s27, 0
    s_mov_b32 s20, s26
    s_mov_b32 s21, s27
    s_mov_b32 s22, 16777216
    s_mov_b32 s23, 0x00020000
    s_mov_b32 s28, 0
    buffer_load_dwordx4 v[40:43], v2, s[20:23], s28 offen
    s_mov_b32 s28, 4194304
    buffer_load_dwordx4 v[44:47], v2, s[20:23], s28 offen
    s_mov_b32 s28, 8388608
    buffer_load_dwordx4 v[48:51], v2, s[20:23], s28 offen
    s_mov_b32 s28, 12582912
    buffer_load_dwordx4 v[52:55], v2, s[20:23], s28 offen
    buffer_load_dwordx2 v[28:29], v10, s[8:11], 0 offen
    buffer_load_dwordx2 v[30:31], v11, s[12:15], 0 offen
    s_waitcnt vmcnt(0)
    v_add_f32 v12, v40, v44
    v_add_f32 v13, v41, v45
    v_add_f32 v14, v42, v46
    v_add_f32 v15, v43, v47
    v_add_f32 v12, v12, v48
    v_add_f32 v13, v13, v49
    v_add_f32 v14, v14, v50
    v_add_f32 v15, v15, v51
    v_add_f32 v12, v12, v52
    v_add_f32 v13, v13, v53
    v_add_f32 v14, v14, v54
    v_add_f32 v15, v15, v55
    v_lshlrev_b32 v16, 16, v28
    v_and_b32 v17, 0xffff0000, v28
    v_lshlrev_b32 v18, 16, v29
    v_and_b32 v19, 0xffff0000, v29
    v_lshlrev_b32 v20, 16, v30
    v_and_b32 v21, 0xffff0000, v30
    v_lshlrev_b32 v22, 16, v31
    v_and_b32 v23, 0xffff0000, v31
    v_add_f32 v12, v12, v20
    v_add_f32 v13, v13, v21
    v_add_f32 v14, v14, v22
    v_add_f32 v15, v15, v23
    v_add_f32 v12, v12, v16
    v_add_f32 v13, v13, v17
    v_add_f32 v14, v14, v18
    v_add_f32 v15, v15, v19
    v_cvt_pk_bf16_f32 v12, v12, v13
    v_cvt_pk_bf16_f32 v13, v14, v15
    buffer_store_dwordx2 v[12:13], v10, s[16:19], 0 offen
RD_EXIT:
    s_endpgm
.section .rodata,"a"
.p2align 6
.amdhsa_kernel ln_kernel
  .amdhsa_next_free_vgpr 64
  .amdhsa_next_free_sgpr 102
  .amdhsa_accum_offset 64
  .amdhsa_group_segment_fixed_size 0
  .amdhsa_kernarg_size 112
  .amdhsa_user_sgpr_count 2
  .amdhsa_user_sgpr_kernarg_segment_ptr 1
  .amdhsa_system_sgpr_workgroup_id_x 1
.end_amdhsa_kernel
.p2align 6
.amdhsa_kernel gemma_kernel
  .amdhsa_next_free_vgpr 256
  .amdhsa_next_free_sgpr 102
  .amdhsa_accum_offset 256
  .amdhsa_group_segment_fixed_size 0
  .amdhsa_kernarg_size 112
  .amdhsa_user_sgpr_count 2
  .amdhsa_user_sgpr_kernarg_segment_ptr 1
  .amdhsa_system_sgpr_workgroup_id_x 1
.end_amdhsa_kernel
.p2align 6
.amdhsa_kernel attn_kernel
  .amdhsa_next_free_vgpr 256
  .amdhsa_next_free_sgpr 102
  .amdhsa_accum_offset 256
  .amdhsa_group_segment_fixed_size 0
  .amdhsa_kernarg_size 112
  .amdhsa_user_sgpr_count 2
  .amdhsa_user_sgpr_kernarg_segment_ptr 1
  .amdhsa_system_sgpr_workgroup_id_x 1
.end_amdhsa_kernel
.p2align 6
.amdhsa_kernel gemmc_kernel
  .amdhsa_next_free_vgpr 136
  .amdhsa_next_free_sgpr 102
  .amdhsa_accum_offset 136
  .amdhsa_group_segment_fixed_size 0
  .amdhsa_kernarg_size 112
  .amdhsa_user_sgpr_count 2
  .amdhsa_user_sgpr_kernarg_segment_ptr 1
  .amdhsa_system_sgpr_workgroup_id_x 1
.end_amdhsa_kernel
.p2align 6
.amdhsa_kernel reduce_kernel
  .amdhsa_next_free_vgpr 80
  .amdhsa_next_free_sgpr 102
  .amdhsa_accum_offset 80
  .amdhsa_group_segment_fixed_size 0
  .amdhsa_kernarg_size 112
  .amdhsa_user_sgpr_count 2
  .amdhsa_user_sgpr_kernarg_segment_ptr 1
  .amdhsa_system_sgpr_workgroup_id_x 1
.end_amdhsa_kernel
```
